```python
import torch

def _softmax(x, axis=-1):
    return torch.softmax(x, dim=axis)
def _gelu(x):
    return torch.nn.functional.gelu(x, approximate="tanh")
def _silu(x):
    return torch.nn.functional.silu(x)
def _sigmoid(x):
    return torch.sigmoid(x)
def _layernorm(x, axis=-1, eps=1e-5):
    m = x.mean(dim=axis, keepdim=True)
    v = x.var(dim=axis, keepdim=True, unbiased=False)
    return (x - m) / torch.sqrt(v + eps)
def _scatter_add(tgt, idx, src, axis=0):
    return tgt.clone().index_add_(axis, idx, src)
def _segment_sum(src, seg, n):
    out = torch.zeros((n,) + src.shape[1:], dtype=src.dtype)
    return out.index_add_(0, seg, src)
def _pad(x, pw):
    flat = tuple(v for pair in reversed(pw) for v in pair)
    return torch.nn.functional.pad(x, flat)

kernel_name = 'concat_heads__sliding_local_dilated__ssm_conv_h3__prompt'

def setup_inputs():

    _w = (lambda a: (lambda t: t.to(torch.bfloat16) if t.is_floating_point() else t)(torch.as_tensor(a)))
    def _A_setup():
        B, S, D = 1, 2048, 640
        return {
            "x": _w((lambda *s: torch.randn(*s, dtype=torch.bfloat16) * 0.2)(B, S, D)),
            "wqkv": _w((lambda *s: torch.randn(*s, dtype=torch.bfloat16) * 0.2)(D, 3 * D)),
            "wo": _w((lambda *s: torch.randn(*s, dtype=torch.bfloat16) * 0.05)(D, D)),
        }
    _A_in = _A_setup()

    def _B_setup():
        B, S, D = 1, 2048, 640
        ks = 4
        return {
            "q": _w((lambda *s: torch.randn(*s, dtype=torch.bfloat16) * 0.05)(B, S, D)),
            "k": _w((lambda *s: torch.randn(*s, dtype=torch.bfloat16) * 0.8)(B, S, D)),
            "v": _w((lambda *s: torch.randn(*s, dtype=torch.bfloat16) * 0.8)(B, S, D)),
            "shift_k": _w((lambda *s: torch.randn(*s, dtype=torch.bfloat16) * 0.8)(D, ks) * 0.5),
            "ssm_k": _w((lambda *s: torch.randn(*s, dtype=torch.bfloat16) * 3.2)(D, S) * (1.0 / S ** 0.5)),
            "ssm_D": _w((lambda *s: torch.randn(*s, dtype=torch.bfloat16) * 0.8)(D)),
        }
    _B_in = _B_setup()

    return {
        "A_x": _A_in["x"],
        "A_wqkv": _A_in["wqkv"],
        "A_wo": _A_in["wo"],
        "B_q": _B_in["q"],
        "B_k": _B_in["k"],
        "B_v": _B_in["v"],
        "B_shift_k": _B_in["shift_k"],
        "B_ssm_k": _B_in["ssm_k"],
        "B_ssm_D": _B_in["ssm_D"],
    }

def reference(A_x, A_wqkv, A_wo, B_q, B_k, B_v, B_shift_k, B_ssm_k, B_ssm_D):
    def _A_ref(x, wqkv, wo):
        B, S, D = x.shape
        H = 32; Dh = D // H
        W, dil = 8, 2
        qkv = (lambda x, *d: x.permute(*d))((x @ wqkv).reshape(B, S, 3, H, Dh), 2, 0, 3, 1, 4)
        q, k, v = qkv[0], qkv[1], qkv[2]
        scale = Dh ** -0.5
        pos = torch.arange(S)
        off = torch.arange(W) * dil
        idx = pos[:, None] - off[None, :]
        mask = idx >= 0
        idx_c = torch.where(mask, idx, 0).reshape(-1)
        kg = k[:, :, idx_c, :].reshape(B, H, S, W, Dh)
        vg = v[:, :, idx_c, :].reshape(B, H, S, W, Dh)
        logits = torch.einsum("bhsd,bhswd->bhsw", q, kg) * scale
        logits = torch.where(mask[None, None, :, :], logits, -1e9)
        attn = _softmax(logits, axis=-1)
        o = torch.einsum("bhsw,bhswd->bhsd", attn, vg)
        return (lambda x, *d: x.permute(*d))(o, 0, 2, 1, 3).reshape(B, S, D) @ wo

    def _B_ref(q, k, v, shift_k, ssm_k, ssm_D):
        B, S, D = q.shape
        ks = shift_k.shape[-1]
        k_pad = _pad(k, ((0, 0), (ks - 1, 0), (0, 0)))
        k_shift = torch.zeros_like(k)
        for t in range(ks):
            k_shift = k_shift + k_pad[:, t:t + S, :] * shift_k[:, ks - 1 - t][None, None, :]
        kv = k_shift * v
        L = 2 * S
        kv_pad = _pad(kv, ((0, 0), (0, S), (0, 0)))
        kf_pad = _pad(ssm_k, ((0, 0), (0, S)))
        kv_f = (lambda x, axes=(-2,-1): torch.fft.rfft2(x.float(), dim=axes))(kv_pad[:, None, :, :], axes=(1, 2))
        kf_f = (lambda x, axes=(-2,-1): torch.fft.rfft2(x.float(), dim=axes))(kf_pad[:, None, :], axes=(1, 2))
        kf_f = (lambda x, *d: x.permute(*d))(kf_f, 1, 2, 0)
        y_f = kv_f * kf_f[None, :, :, :]
        y = (lambda x, s, axes=(-2,-1): torch.fft.irfft2(x, s=s, dim=axes).to(torch.bfloat16))(y_f, (1, L), axes=(1, 2))[:, 0, :S, :]
        y = y + kv * ssm_D[None, None, :]
        return q * y

    a = _A_ref(A_x, A_wqkv, A_wo)
    b = _B_ref(B_q, B_k, B_v, B_shift_k, B_ssm_k, B_ssm_D)
    return torch.concatenate([a, b], axis=-1)
```

```asm
; @launch grid=(512,1,1) block=(256,1,1) lds=81920
.amdgcn_target "amdgcn-amd-amdhsa--gfx950"
.text
.globl concat_heads__sliding_local_dilated__ssm_conv_h3__prompt_kernel
.p2align 8
.type concat_heads__sliding_local_dilated__ssm_conv_h3__prompt_kernel,@function
concat_heads__sliding_local_dilated__ssm_conv_h3__prompt_kernel:
L_start_5:
    s_cmp_ge_u32 s2, 512
    s_cbranch_scc1 L_end_1
    s_load_dwordx16 s[16:31], s[0:1], 0
    s_load_dwordx8 s[32:39], s[0:1], 64
    s_getpc_b64 s[4:5]
    s_bfe_u32 s6, s2, 0x50003
    s_lshl_b32 s6, s6, 11
    v_lshlrev_b32 v1, 7, v0
    v_add_u32 v1, s6, v1
    v_cmp_gt_u32 vcc, (L_end_1-L_start_5-64), v1
    s_nop 1
    s_mov_b64 s[6:7], vcc
    v_cmp_gt_u32 vcc, 16, v0
    s_nop 1
    s_and_b64 vcc, vcc, s[6:7]
    s_nop 0
    s_and_saveexec_b64 s[6:7], vcc
    s_cbranch_execz L_nopf_7
    global_load_dword v250, v1, s[4:5]
L_nopf_7:
    s_mov_b64 exec, s[6:7]
    v_lshrrev_b32 v1, 6, v0
    v_and_b32 v0, 63, v0
    v_readfirstlane_b32 s3, v1
    s_nop 1
    s_or_b32 s7, s2, s3
    s_cmp_lg_u32 s7, 0
    s_cbranch_scc1 L_nopub_8
    s_setprio 3
    s_waitcnt lgkmcnt(0)
    s_mov_b32 s8, s36
    s_mov_b32 s9, s37
    s_mov_b32 s10, 0x100
    s_mov_b32 s11, 0x20000
    s_memrealtime s[100:101]
    s_waitcnt lgkmcnt(0)
    s_or_b32 s100, s100, 1
    v_mov_b32 v248, s100
    v_mov_b32 v249, 0
    s_mov_b64 exec, 1
    buffer_store_dword v248, v249, s[8:11], 0 offen sc1
    s_mov_b64 exec, -1
    s_setprio 0
L_nopub_8:
    s_cmp_ge_u32 s2, 416
    s_cbranch_scc1 L_prole_3
    s_cmp_lt_u32 s2, 160
    s_cbranch_scc1 L_brole_9
    s_setprio 2
    s_sub_u32 s57, s2, 160
    s_and_b32 s58, s57, 7
    s_lshr_b32 s59, s57, 3
    s_lshr_b32 s4, s58, 1
    s_lshl_b32 s4, s4, 2
    s_and_b32 s5, s58, 1
    s_lshl_b32 s5, s5, 3
    s_mul_i32 s57, s59, 43
    s_lshr_b32 s57, s57, 7
    s_mul_i32 s58, s57, 3
    s_sub_u32 s58, s59, s58
    s_lshl_b32 s58, s58, 2
    s_lshr_b32 s58, 0x431, s58
    s_and_b32 s58, s58, 7
    s_sub_u32 s60, s59, 12
    s_cmp_ge_u32 s59, 12
    s_cselect_b32 s57, s60, s57
    s_cselect_b32 s58, 6, s58
    s_bfe_u32 s60, s59, 0x20002
    s_cmp_ge_u32 s59, 16
    s_cselect_b32 s57, s60, s57
    s_and_b32 s60, s59, 3
    s_lshl_b32 s60, s60, 2
    s_lshr_b32 s60, 0x7520, s60
    s_and_b32 s60, s60, 7
    s_cmp_ge_u32 s59, 16
    s_cselect_b32 s58, s60, s58
    s_add_u32 s4, s4, s57
    s_add_u32 s5, s5, s58
    s_sub_u32 s60, s59, 16
    s_add_u32 s99, s60, 12
    s_cmp_lt_u32 s60, 8
    s_cselect_b32 s99, s99, 99
    v_lshrrev_b32 v20, 3, v0
    v_and_b32 v21, 7, v0
    s_and_b32 s57, s3, 1
    s_lshl_b32 s57, s57, 2
    v_lshrrev_b32 v22, 1, v20
    v_add_u32 v22, s57, v22
    v_xor_b32 v22, v21, v22
    v_mul_u32_u24 v2, 1280, v20
    v_lshl_add_u32 v2, v22, 4, v2
    s_and_b32 s80, s4, 3
    s_mul_i32 s80, s80, 3
    s_and_b32 s57, s5, 7
    s_add_u32 s80, s80, s57
    s_sub_u32 s57, s80, 10
    s_cmp_ge_u32 s80, 10
    s_cselect_b32 s80, s57, s80
    s_lshl_b32 s81, s80, 1
    s_lshl_b32 s57, s80, 7
    v_add_u32 v2, s57, v2
    s_mul_i32 s60, s81, 122880
    s_sub_u32 s80, 9, s80
    s_sub_u32 s81, 19, s81
    s_mov_b32 s100, 122880
    s_mov_b32 s101, 4292632576
    s_movk_i32 s56, 128
    s_mov_b32 s7, 4294966144
    s_lshl_b32 s57, s4, 7
    s_lshl_b32 s58, s3, 3
    s_add_i32 s57, s57, s58
    s_sub_i32 s57, s57, 16
    s_add_i32 s58, s57, 0
    s_max_i32 s58, s58, 0
    s_mul_i32 s63, s58, 1280
    s_add_i32 s58, s57, 32
    s_mul_i32 s64, s58, 1280
    s_add_i32 s58, s57, 64
    s_mul_i32 s65, s58, 1280
    s_add_i32 s58, s57, 96
    s_mul_i32 s66, s58, 1280
    s_add_i32 s58, s57, 128
    s_mul_i32 s67, s58, 1280
    s_lshl_b32 s68, s3, 10
    s_add_u32 s69, s68, 24576
    s_cmp_lt_u32 s3, 2
    s_cselect_b32 s67, s67, 0x40000000
    s_add_u32 s58, s69, 16384
    s_cmp_lt_u32 s3, 2
    s_cselect_b32 s70, s58, 79872
    s_add_u32 s58, s69, 34816
    s_cmp_lt_u32 s3, 2
    s_cselect_b32 s71, s58, 79872
    s_add_u32 s58, s69, 53248
    s_cmp_lt_u32 s3, 2
    s_cselect_b32 s72, s58, 79872
    v_lshrrev_b32 v20, 4, v0
    v_and_b32 v21, 15, v0
    s_bfe_u32 s57, s3, 0x10001
    s_lshl_b32 s57, s57, 3
    v_lshl_add_u32 v22, v20, 1, s57
    v_sub_u32 v22, v21, v22
    v_and_b32 v22, 15, v22
    v_min_u32 v22, 14, v22
    v_mul_u32_u24 v23, 52, v22
    v_lshrrev_b32 v23, 8, v23
    v_mul_u32_u24 v24, 5, v23
    v_sub_u32 v24, v22, v24
    v_mul_u32_u24 v1, 3840, v20
    v_mul_u32_u24 v23, 1280, v23
    v_add_u32 v1, v1, v23
    v_lshl_add_u32 v1, v24, 4, v1
    s_mul_i32 s57, s5, 80
    s_add_u32 s57, s57, s60
    v_add_u32 v1, s57, v1
    s_mul_i32 s61, s3, 15360
    s_add_u32 s62, s61, 61440
    s_waitcnt lgkmcnt(0)
    s_mov_b32 s40, s16
    s_mov_b32 s41, s17
    s_mov_b32 s42, 0x280000
    s_mov_b32 s43, 0x20000
    s_add_u32 m0, s69, 0
    s_nop 0
    buffer_load_dwordx4 v2, s[40:43], s63 offen lds
    s_add_u32 m0, s69, 4096
    s_nop 0
    buffer_load_dwordx4 v2, s[40:43], s64 offen lds
    s_add_u32 m0, s69, 8192
    s_nop 0
    buffer_load_dwordx4 v2, s[40:43], s65 offen lds
    s_add_u32 m0, s69, 12288
    s_nop 0
    buffer_load_dwordx4 v2, s[40:43], s66 offen lds
    s_mov_b32 m0, s70
    s_nop 0
    buffer_load_dwordx4 v2, s[40:43], s67 offen lds
    s_sub_u32 s80, s80, 1
    s_cselect_b32 s73, s7, s56
    v_add_u32 v2, s73, v2
    s_mov_b32 s44, s18
    s_mov_b32 s45, s19
    s_mov_b32 s46, 0x258000
    s_mov_b32 s47, 0x20000
    s_add_u32 m0, s68, 0
    s_nop 0
    buffer_load_dwordx4 v1, s[44:47], s61 offen lds
    s_add_u32 m0, s68, 4096
    s_nop 0
    buffer_load_dwordx4 v1, s[44:47], s62 offen lds
    s_sub_u32 s81, s81, 1
    s_cselect_b32 s73, s101, s100
    v_add_u32 v1, s73, v1
    s_mov_b32 s8, s36
    s_mov_b32 s9, s37
    s_mov_b32 s10, 0x100
    s_mov_b32 s11, 0x20000
    s_add_u32 s12, s38, 0x780000
    s_addc_u32 s13, s39, 0
    s_mov_b32 s14, 0x10000
    s_mov_b32 s15, 0x20000
    s_mov_b32 s6, 0
    s_mov_b32 s48, s38
    s_mov_b32 s49, s39
    s_mov_b32 s50, 0x280000
    s_mov_b32 s51, 0x20000
    v_lshrrev_b32 v20, 4, v0
    v_bfe_u32 v21, v0, 2, 2
    v_and_b32 v22, 3, v0
    v_lshl_add_u32 v23, v20, 3, v21
    v_lshlrev_b32 v23, 8, v23
    v_and_b32 v24, 1, v20
    v_lshlrev_b32 v24, 7, v24
    v_lshl_add_u32 v24, v21, 5, v24
    v_lshl_add_u32 v25, v22, 3, v24
    v_add_u32 v25, 0, v25
    v_and_b32 v25, 255, v25
    v_add_u32 v4, v23, v25
    v_lshl_add_u32 v25, v22, 3, v24
    v_add_u32 v25, 40, v25
    v_and_b32 v25, 255, v25
    v_add_u32 v5, v23, v25
    v_lshl_add_u32 v25, v22, 3, v24
    v_add_u32 v25, 80, v25
    v_and_b32 v25, 255, v25
    v_add_u32 v6, v23, v25
    v_lshl_add_u32 v25, v22, 3, v24
    v_add_u32 v25, 120, v25
    v_and_b32 v25, 255, v25
    v_add_u32 v7, v23, v25
    v_mul_u32_u24 v25, 40, v22
    v_add_u32 v25, v25, v24
    v_add_u32 v25, 32, v25
    v_and_b32 v25, 255, v25
    v_add_u32 v8, v23, v25
    v_lshl_add_u32 v25, v22, 3, v24
    v_add_u32 v25, 160, v25
    v_and_b32 v25, 255, v25
    v_add_u32 v9, v23, v25
    v_lshl_add_u32 v25, v22, 3, v24
    v_add_u32 v25, 200, v25
    v_and_b32 v25, 255, v25
    v_add_u32 v10, v23, v25
    v_mul_u32_u24 v25, 40, v22
    v_add_u32 v25, 192, v25
    v_lshlrev_b32 v11, 3, v22
    v_add_u32 v11, 160, v11
    v_cmp_gt_u32 vcc, 2, v22
    s_nop 1
    v_cndmask_b32 v25, v11, v25, vcc
    v_add_u32 v25, v25, v24
    v_and_b32 v25, 255, v25
    v_add_u32 v11, v23, v25
    v_and_b32 v21, 15, v0
    v_bfe_u32 v22, v0, 1, 3
    v_xor_b32 v22, v20, v22
    v_lshlrev_b32 v21, 7, v21
    v_lshl_add_u32 v12, v22, 4, v21
    v_xor_b32 v13, 64, v12
    v_add_u32 v12, 24576, v12
    v_add_u32 v13, 24576, v13
    v_mov_b32 v16, v6
    v_mov_b32 v17, v9
    s_cmp_eq_u32 s3, 1
    s_cselect_b64 vcc, -1, 0
    v_cndmask_b32 v16, v16, v7, vcc
    v_cndmask_b32 v17, v17, v10, vcc
    s_cmp_eq_u32 s3, 2
    s_cselect_b64 vcc, -1, 0
    v_cndmask_b32 v16, v16, v8, vcc
    v_cndmask_b32 v17, v17, v11, vcc
    s_lshl_b32 s57, s3, 12
    s_add_u32 s57, s57, 2048
    v_add_u32 v18, s57, v12
    v_add_u32 v19, s57, v13
    s_add_u32 m0, s69, 18432
    s_nop 0
    buffer_load_dwordx4 v2, s[40:43], s63 offen lds
    s_add_u32 m0, s69, 22528
    s_nop 0
    buffer_load_dwordx4 v2, s[40:43], s64 offen lds
    s_add_u32 m0, s69, 26624
    s_nop 0
    buffer_load_dwordx4 v2, s[40:43], s65 offen lds
    s_add_u32 m0, s69, 30720
    s_nop 0
    buffer_load_dwordx4 v2, s[40:43], s66 offen lds
    s_mov_b32 m0, s71
    s_nop 0
    buffer_load_dwordx4 v2, s[40:43], s67 offen lds
    s_sub_u32 s80, s80, 1
    s_cselect_b32 s73, s7, s56
    v_add_u32 v2, s73, v2
    s_add_u32 m0, s68, 8192
    s_nop 0
    buffer_load_dwordx4 v1, s[44:47], s61 offen lds
    s_add_u32 m0, s68, 12288
    s_nop 0
    buffer_load_dwordx4 v1, s[44:47], s62 offen lds
    s_sub_u32 s81, s81, 1
    s_cselect_b32 s73, s101, s100
    v_add_u32 v1, s73, v1
    v_mov_b64 v[48:49], 0
    v_mov_b64 v[50:51], 0
    v_mov_b64 v[52:53], 0
    v_mov_b64 v[54:55], 0
    v_mov_b64 v[56:57], 0
    v_mov_b64 v[58:59], 0
    v_mov_b64 v[60:61], 0
    v_mov_b64 v[62:63], 0
    v_mov_b64 v[64:65], 0
    v_mov_b64 v[66:67], 0
    v_mov_b64 v[68:69], 0
    v_mov_b64 v[70:71], 0
    v_mov_b64 v[72:73], 0
    v_mov_b64 v[74:75], 0
    v_mov_b64 v[76:77], 0
    v_mov_b64 v[78:79], 0
    v_mov_b64 v[80:81], 0
    v_mov_b64 v[82:83], 0
    v_mov_b64 v[84:85], 0
    v_mov_b64 v[86:87], 0
    v_mov_b64 v[88:89], 0
    v_mov_b64 v[90:91], 0
    v_mov_b64 v[92:93], 0
    v_mov_b64 v[94:95], 0
    v_mov_b64 v[96:97], 0
    v_mov_b64 v[98:99], 0
    v_mov_b64 v[100:101], 0
    v_mov_b64 v[102:103], 0
    v_mov_b64 v[104:105], 0
    v_mov_b64 v[106:107], 0
    v_mov_b64 v[108:109], 0
    v_mov_b64 v[110:111], 0
    v_mov_b64 v[112:113], 0
    v_mov_b64 v[114:115], 0
    v_mov_b64 v[116:117], 0
    v_mov_b64 v[118:119], 0
    s_mul_i32 s52, s3, 3072
    s_add_u32 s52, s52, 43008
    v_lshl_add_u32 v28, v0, 3, s52
    v_add_u32 v26, 3072, v28
    s_lshl_b32 s53, s3, 9
    s_cmp_lt_u32 s3, 3
    s_cselect_b32 s53, s53, 15360
    s_add_u32 s53, s53, 43008
    v_lshl_add_u32 v27, v0, 3, s53
    v_and_b32 v20, 15, v0
    v_lshrrev_b32 v21, 4, v0
    v_lshlrev_b32 v21, 2, v21
    v_sub_u32 v20, v20, v21
    v_mov_b32 v22, 0xf149f2ca
    v_add_u32 v21, 0, v20
    v_and_b32 v23, 0xfffffff1, v21
    v_cmp_eq_u32 vcc, 0, v23
    s_nop 1
    v_cndmask_b32_e64 v32, v22, 0, vcc
    v_add_u32 v21, 16, v20
    v_and_b32 v23, 0xfffffff1, v21
    v_cmp_eq_u32 vcc, 0, v23
    s_nop 1
    v_cndmask_b32_e64 v36, v22, 0, vcc
    v_add_u32 v21, -1, v20
    v_and_b32 v23, 0xfffffff1, v21
    v_cmp_eq_u32 vcc, 0, v23
    s_nop 1
    v_cndmask_b32_e64 v33, v22, 0, vcc
    v_add_u32 v21, 15, v20
    v_and_b32 v23, 0xfffffff1, v21
    v_cmp_eq_u32 vcc, 0, v23
    s_nop 1
    v_cndmask_b32_e64 v37, v22, 0, vcc
    v_add_u32 v21, -2, v20
    v_and_b32 v23, 0xfffffff1, v21
    v_cmp_eq_u32 vcc, 0, v23
    s_nop 1
    v_cndmask_b32_e64 v34, v22, 0, vcc
    v_add_u32 v21, 14, v20
    v_and_b32 v23, 0xfffffff1, v21
    v_cmp_eq_u32 vcc, 0, v23
    s_nop 1
    v_cndmask_b32_e64 v38, v22, 0, vcc
    v_add_u32 v21, -3, v20
    v_and_b32 v23, 0xfffffff1, v21
    v_cmp_eq_u32 vcc, 0, v23
    s_nop 1
    v_cndmask_b32_e64 v35, v22, 0, vcc
    v_add_u32 v21, 13, v20
    v_and_b32 v23, 0xfffffff1, v21
    v_cmp_eq_u32 vcc, 0, v23
    s_nop 1
    v_cndmask_b32_e64 v39, v22, 0, vcc
    s_or_b32 s52, s4, s3
    s_cmp_eq_u32 s52, 0
    s_cselect_b64 vcc, -1, 0
    v_cndmask_b32 v40, v36, v22, vcc
    v_cndmask_b32 v41, v37, v22, vcc
    v_cndmask_b32 v42, v38, v22, vcc
    v_cndmask_b32 v43, v39, v22, vcc
    v_mov_b32 v44, 0x3f803f80
    v_mov_b32 v45, 0x3f803f80
    v_mov_b32 v46, 0x3f803f80
    v_mov_b32 v47, 0x3f803f80
    s_mov_b32 s75, 0x3ea52b5c
    s_mov_b32 s76, 0xffff
    s_mov_b32 s77, 0
    s_mov_b32 s78, 0xffff0000
    s_mov_b32 s79, 0
    s_lshl_b32 s52, s4, 3
    s_lshl_b32 s53, s3, 1
    s_add_u32 s52, s52, s53
    s_mul_i32 s52, s52, 20480
    s_lshl_b32 s53, s5, 10
    s_add_u32 s53, s53, s52
    v_lshl_add_u32 v29, v0, 4, s53
    s_mov_b32 s54, 0xb6a21908
    s_mov_b32 s55, 0xf7e54d3c
    s_cmp_ge_u32 s5, 8
    s_cselect_b32 s54, s55, s54
    s_and_b32 s53, s5, 7
    s_lshl_b32 s53, s53, 2
    s_lshr_b32 s54, s54, s53
    s_and_b32 s54, s54, 15
    s_lshl_b32 s53, s54, 8
    s_add_u32 s53, s53, 16384
    s_add_u32 s53, s53, s52
    v_and_b32 v20, 15, v0
    v_lshlrev_b32 v20, 4, v20
    v_bfe_u32 v21, v0, 4, 1
    v_lshl_add_u32 v20, v21, 3, v20
    v_add_u32 v30, s53, v20
    s_mov_b32 s54, 0x3ea52b5c
    s_mov_b32 s55, 0x3ea52b5c
    s_add_u32 m0, s68, 16384
    s_nop 0
    buffer_load_dwordx4 v1, s[44:47], s61 offen lds
    s_add_u32 m0, s68, 20480
    s_nop 0
    buffer_load_dwordx4 v1, s[44:47], s62 offen lds
    s_sub_u32 s81, s81, 1
    s_cselect_b32 s73, s101, s100
    v_add_u32 v1, s73, v1
    s_add_u32 m0, s69, 36864
    s_nop 0
    buffer_load_dwordx4 v2, s[40:43], s63 offen lds
    s_add_u32 m0, s69, 40960
    s_nop 0
    buffer_load_dwordx4 v2, s[40:43], s64 offen lds
    s_add_u32 m0, s69, 45056
    s_nop 0
    buffer_load_dwordx4 v2, s[40:43], s65 offen lds
    s_add_u32 m0, s69, 49152
    s_nop 0
    buffer_load_dwordx4 v2, s[40:43], s66 offen lds
    s_mov_b32 m0, s72
    s_nop 0
    buffer_load_dwordx4 v2, s[40:43], s67 offen lds
    s_sub_u32 s80, s80, 1
    s_cselect_b32 s73, s7, s56
    v_add_u32 v2, s73, v2
    s_waitcnt vmcnt(14)
    s_barrier
    ds_read_b128 v[200:203], v18 offset:0
    ds_read_b128 v[204:207], v18 offset:2048
    ds_read_b64_tr_b16 v[120:121], v4 offset:0
    ds_read_b64_tr_b16 v[122:123], v4 offset:1024
    ds_read_b64_tr_b16 v[124:125], v5 offset:0
    ds_read_b64_tr_b16 v[126:127], v5 offset:1024
    ds_read_b64_tr_b16 v[128:129], v6 offset:0
    ds_read_b64_tr_b16 v[130:131], v6 offset:1024
    ds_read_b64_tr_b16 v[132:133], v7 offset:0
    ds_read_b64_tr_b16 v[134:135], v7 offset:1024
    ds_read_b64_tr_b16 v[136:137], v8 offset:0
    ds_read_b64_tr_b16 v[138:139], v8 offset:1024
    ds_read_b64_tr_b16 v[140:141], v9 offset:0
    ds_read_b64_tr_b16 v[142:143], v9 offset:1024
    ds_read_b64_tr_b16 v[144:145], v10 offset:0
    ds_read_b64_tr_b16 v[146:147], v10 offset:1024
    ds_read_b64_tr_b16 v[148:149], v11 offset:0
    ds_read_b64_tr_b16 v[150:151], v11 offset:1024
    ds_read_b128 v[208:211], v12 offset:0
    ds_read_b64_tr_b16 v[184:185], v16 offset:0
    ds_read_b64_tr_b16 v[186:187], v16 offset:1024
    ds_read_b64_tr_b16 v[188:189], v17 offset:0
    ds_read_b64_tr_b16 v[190:191], v17 offset:1024
    s_mov_b32 s74, 0
L_a1loop_10:
    s_waitcnt vmcnt(7) lgkmcnt(0)
    s_barrier
    v_mfma_f32_16x16x32_bf16 v[48:51], v[120:123], v[200:203], v[48:51]
    ds_read_b128 v[212:215], v19 offset:0
    ds_read_b128 v[216:219], v19 offset:2048
    s_add_u32 m0, s68, 0
    v_mfma_f32_16x16x32_bf16 v[80:83], v[120:123], v[204:207], v[80:83]
    ds_read_b64_tr_b16 v[152:153], v4 offset:8192
    buffer_load_dwordx4 v1, s[44:47], s61 offen lds
    v_mfma_f32_16x16x32_bf16 v[52:55], v[124:127], v[200:203], v[52:55]
    ds_read_b64_tr_b16 v[154:155], v4 offset:9216
    ds_read_b64_tr_b16 v[156:157], v5 offset:8192
    s_add_u32 m0, s68, 4096
    v_mfma_f32_16x16x32_bf16 v[84:87], v[124:127], v[204:207], v[84:87]
    ds_read_b64_tr_b16 v[158:159], v5 offset:9216
    buffer_load_dwordx4 v1, s[44:47], s62 offen lds
    v_mfma_f32_16x16x32_bf16 v[56:59], v[128:131], v[200:203], v[56:59]
    ds_read_b64_tr_b16 v[160:161], v6 offset:8192
    ds_read_b64_tr_b16 v[162:163], v6 offset:9216
    v_mfma_f32_16x16x32_bf16 v[88:91], v[128:131], v[204:207], v[88:91]
    ds_read_b64_tr_b16 v[164:165], v7 offset:8192
    s_sub_u32 s81, s81, 1
    s_cselect_b32 s73, s101, s100
    v_add_u32 v1, s73, v1
    v_mfma_f32_16x16x32_bf16 v[60:63], v[132:135], v[200:203], v[60:63]
    ds_read_b64_tr_b16 v[166:167], v7 offset:9216
    ds_read_b64_tr_b16 v[168:169], v8 offset:8192
    v_mfma_f32_16x16x32_bf16 v[92:95], v[132:135], v[204:207], v[92:95]
    ds_read_b64_tr_b16 v[170:171], v8 offset:9216
    ds_read_b64_tr_b16 v[172:173], v9 offset:8192
    v_mfma_f32_16x16x32_bf16 v[64:67], v[136:139], v[200:203], v[64:67]
    ds_read_b64_tr_b16 v[174:175], v9 offset:9216
    v_mfma_f32_16x16x32_bf16 v[96:99], v[136:139], v[204:207], v[96:99]
    ds_read_b64_tr_b16 v[176:177], v10 offset:8192
    v_mfma_f32_16x16x32_bf16 v[68:71], v[200:203], v[140:143], v[68:71]
    ds_read_b64_tr_b16 v[178:179], v10 offset:9216
    v_mfma_f32_16x16x32_bf16 v[100:103], v[204:207], v[140:143], v[100:103]
    ds_read_b64_tr_b16 v[180:181], v11 offset:8192
    v_mfma_f32_16x16x32_bf16 v[72:75], v[200:203], v[144:147], v[72:75]
    ds_read_b64_tr_b16 v[182:183], v11 offset:9216
    v_mfma_f32_16x16x32_bf16 v[104:107], v[204:207], v[144:147], v[104:107]
    ds_read_b128 v[220:223], v13 offset:0
    v_mfma_f32_16x16x32_bf16 v[76:79], v[200:203], v[148:151], v[76:79]
    ds_read_b64_tr_b16 v[192:193], v16 offset:8192
    v_mfma_f32_16x16x32_bf16 v[108:111], v[204:207], v[148:151], v[108:111]
    ds_read_b64_tr_b16 v[194:195], v16 offset:9216
    v_mfma_f32_16x16x32_bf16 v[112:115], v[184:187], v[208:211], v[112:115]
    ds_read_b64_tr_b16 v[196:197], v17 offset:8192
    v_mfma_f32_16x16x32_bf16 v[116:119], v[208:211], v[188:191], v[116:119]
    ds_read_b64_tr_b16 v[198:199], v17 offset:9216
    s_waitcnt vmcnt(7) lgkmcnt(0)
    s_barrier
    v_mfma_f32_16x16x32_bf16 v[48:51], v[152:155], v[212:215], v[48:51]
    ds_read_b128 v[200:203], v18 offset:18432
    ds_read_b128 v[204:207], v18 offset:20480
    s_add_u32 m0, s68, 8192
    v_mfma_f32_16x16x32_bf16 v[80:83], v[152:155], v[216:219], v[80:83]
    ds_read_b64_tr_b16 v[120:121], v4 offset:16384
    buffer_load_dwordx4 v1, s[44:47], s61 offen lds
    v_mfma_f32_16x16x32_bf16 v[52:55], v[156:159], v[212:215], v[52:55]
    ds_read_b64_tr_b16 v[122:123], v4 offset:17408
    ds_read_b64_tr_b16 v[124:125], v5 offset:16384
    s_add_u32 m0, s68, 12288
    v_mfma_f32_16x16x32_bf16 v[84:87], v[156:159], v[216:219], v[84:87]
    ds_read_b64_tr_b16 v[126:127], v5 offset:17408
    buffer_load_dwordx4 v1, s[44:47], s62 offen lds
    v_mfma_f32_16x16x32_bf16 v[56:59], v[160:163], v[212:215], v[56:59]
    ds_read_b64_tr_b16 v[128:129], v6 offset:16384
    ds_read_b64_tr_b16 v[130:131], v6 offset:17408
    v_mfma_f32_16x16x32_bf16 v[88:91], v[160:163], v[216:219], v[88:91]
    ds_read_b64_tr_b16 v[132:133], v7 offset:16384
    s_sub_u32 s81, s81, 1
    s_cselect_b32 s73, s101, s100
    v_add_u32 v1, s73, v1
    v_mfma_f32_16x16x32_bf16 v[60:63], v[164:167], v[212:215], v[60:63]
    ds_read_b64_tr_b16 v[134:135], v7 offset:17408
    ds_read_b64_tr_b16 v[136:137], v8 offset:16384
    s_add_u32 m0, s69, 0
    v_mfma_f32_16x16x32_bf16 v[92:95], v[164:167], v[216:219], v[92:95]
    ds_read_b64_tr_b16 v[138:139], v8 offset:17408
    buffer_load_dwordx4 v2, s[40:43], s63 offen lds
    v_mfma_f32_16x16x32_bf16 v[64:67], v[168:171], v[212:215], v[64:67]
    ds_read_b64_tr_b16 v[140:141], v9 offset:16384
    ds_read_b64_tr_b16 v[142:143], v9 offset:17408
    s_add_u32 m0, s69, 4096
    v_mfma_f32_16x16x32_bf16 v[96:99], v[168:171], v[216:219], v[96:99]
    ds_read_b64_tr_b16 v[144:145], v10 offset:16384
    buffer_load_dwordx4 v2, s[40:43], s64 offen lds
    v_mfma_f32_16x16x32_bf16 v[68:71], v[212:215], v[172:175], v[68:71]
    ds_read_b64_tr_b16 v[146:147], v10 offset:17408
    ds_read_b64_tr_b16 v[148:149], v11 offset:16384
    s_add_u32 m0, s69, 8192
    v_mfma_f32_16x16x32_bf16 v[100:103], v[216:219], v[172:175], v[100:103]
    ds_read_b64_tr_b16 v[150:151], v11 offset:17408
    buffer_load_dwordx4 v2, s[40:43], s65 offen lds
    v_mfma_f32_16x16x32_bf16 v[72:75], v[212:215], v[176:179], v[72:75]
    ds_read_b128 v[208:211], v12 offset:18432
    ds_read_b64_tr_b16 v[184:185], v16 offset:16384
    s_add_u32 m0, s69, 12288
    v_mfma_f32_16x16x32_bf16 v[104:107], v[216:219], v[176:179], v[104:107]
    ds_read_b64_tr_b16 v[186:187], v16 offset:17408
    buffer_load_dwordx4 v2, s[40:43], s66 offen lds
    v_mfma_f32_16x16x32_bf16 v[76:79], v[212:215], v[180:183], v[76:79]
    ds_read_b64_tr_b16 v[188:189], v17 offset:16384
    v_mfma_f32_16x16x32_bf16 v[108:111], v[216:219], v[180:183], v[108:111]
    ds_read_b64_tr_b16 v[190:191], v17 offset:17408
    s_mov_b32 m0, s70
    v_mfma_f32_16x16x32_bf16 v[112:115], v[192:195], v[220:223], v[112:115]
    buffer_load_dwordx4 v2, s[40:43], s67 offen lds
    v_mfma_f32_16x16x32_bf16 v[116:119], v[220:223], v[196:199], v[116:119]
    s_sub_u32 s80, s80, 1
    s_cselect_b32 s73, s7, s56
    v_add_u32 v2, s73, v2
    s_waitcnt vmcnt(7) lgkmcnt(0)
    s_barrier
    v_mfma_f32_16x16x32_bf16 v[48:51], v[120:123], v[200:203], v[48:51]
    ds_read_b128 v[212:215], v19 offset:18432
    ds_read_b128 v[216:219], v19 offset:20480
    s_add_u32 m0, s68, 16384
    v_mfma_f32_16x16x32_bf16 v[80:83], v[120:123], v[204:207], v[80:83]
    ds_read_b64_tr_b16 v[152:153], v4 offset:0
    buffer_load_dwordx4 v1, s[44:47], s61 offen lds
    v_mfma_f32_16x16x32_bf16 v[52:55], v[124:127], v[200:203], v[52:55]
    ds_read_b64_tr_b16 v[154:155], v4 offset:1024
    ds_read_b64_tr_b16 v[156:157], v5 offset:0
    s_add_u32 m0, s68, 20480
    v_mfma_f32_16x16x32_bf16 v[84:87], v[124:127], v[204:207], v[84:87]
    ds_read_b64_tr_b16 v[158:159], v5 offset:1024
    buffer_load_dwordx4 v1, s[44:47], s62 offen lds
    v_mfma_f32_16x16x32_bf16 v[56:59], v[128:131], v[200:203], v[56:59]
    ds_read_b64_tr_b16 v[160:161], v6 offset:0
    ds_read_b64_tr_b16 v[162:163], v6 offset:1024
    v_mfma_f32_16x16x32_bf16 v[88:91], v[128:131], v[204:207], v[88:91]
    ds_read_b64_tr_b16 v[164:165], v7 offset:0
    s_sub_u32 s81, s81, 1
    s_cselect_b32 s73, s101, s100
    v_add_u32 v1, s73, v1
    v_mfma_f32_16x16x32_bf16 v[60:63], v[132:135], v[200:203], v[60:63]
    ds_read_b64_tr_b16 v[166:167], v7 offset:1024
    ds_read_b64_tr_b16 v[168:169], v8 offset:0
    v_mfma_f32_16x16x32_bf16 v[92:95], v[132:135], v[204:207], v[92:95]
    ds_read_b64_tr_b16 v[170:171], v8 offset:1024
    ds_read_b64_tr_b16 v[172:173], v9 offset:0
    v_mfma_f32_16x16x32_bf16 v[64:67], v[136:139], v[200:203], v[64:67]
    ds_read_b64_tr_b16 v[174:175], v9 offset:1024
    v_mfma_f32_16x16x32_bf16 v[96:99], v[136:139], v[204:207], v[96:99]
    ds_read_b64_tr_b16 v[176:177], v10 offset:0
    v_mfma_f32_16x16x32_bf16 v[68:71], v[200:203], v[140:143], v[68:71]
    ds_read_b64_tr_b16 v[178:179], v10 offset:1024
    v_mfma_f32_16x16x32_bf16 v[100:103], v[204:207], v[140:143], v[100:103]
    ds_read_b64_tr_b16 v[180:181], v11 offset:0
    v_mfma_f32_16x16x32_bf16 v[72:75], v[200:203], v[144:147], v[72:75]
    ds_read_b64_tr_b16 v[182:183], v11 offset:1024
    v_mfma_f32_16x16x32_bf16 v[104:107], v[204:207], v[144:147], v[104:107]
    ds_read_b128 v[220:223], v13 offset:18432
    v_mfma_f32_16x16x32_bf16 v[76:79], v[200:203], v[148:151], v[76:79]
    ds_read_b64_tr_b16 v[192:193], v16 offset:0
    v_mfma_f32_16x16x32_bf16 v[108:111], v[204:207], v[148:151], v[108:111]
    ds_read_b64_tr_b16 v[194:195], v16 offset:1024
    v_mfma_f32_16x16x32_bf16 v[112:115], v[184:187], v[208:211], v[112:115]
    ds_read_b64_tr_b16 v[196:197], v17 offset:0
    v_mfma_f32_16x16x32_bf16 v[116:119], v[208:211], v[188:191], v[116:119]
    ds_read_b64_tr_b16 v[198:199], v17 offset:1024
    s_waitcnt vmcnt(7) lgkmcnt(0)
    s_barrier
    v_mfma_f32_16x16x32_bf16 v[48:51], v[152:155], v[212:215], v[48:51]
    ds_read_b128 v[200:203], v18 offset:36864
    ds_read_b128 v[204:207], v18 offset:38912
    s_add_u32 m0, s68, 0
    v_mfma_f32_16x16x32_bf16 v[80:83], v[152:155], v[216:219], v[80:83]
    ds_read_b64_tr_b16 v[120:121], v4 offset:8192
    buffer_load_dwordx4 v1, s[44:47], s61 offen lds
    v_mfma_f32_16x16x32_bf16 v[52:55], v[156:159], v[212:215], v[52:55]
    ds_read_b64_tr_b16 v[122:123], v4 offset:9216
    ds_read_b64_tr_b16 v[124:125], v5 offset:8192
    s_add_u32 m0, s68, 4096
    v_mfma_f32_16x16x32_bf16 v[84:87], v[156:159], v[216:219], v[84:87]
    ds_read_b64_tr_b16 v[126:127], v5 offset:9216
    buffer_load_dwordx4 v1, s[44:47], s62 offen lds
    v_mfma_f32_16x16x32_bf16 v[56:59], v[160:163], v[212:215], v[56:59]
    ds_read_b64_tr_b16 v[128:129], v6 offset:8192
    ds_read_b64_tr_b16 v[130:131], v6 offset:9216
    v_mfma_f32_16x16x32_bf16 v[88:91], v[160:163], v[216:219], v[88:91]
    ds_read_b64_tr_b16 v[132:133], v7 offset:8192
    s_sub_u32 s81, s81, 1
    s_cselect_b32 s73, s101, s100
    v_add_u32 v1, s73, v1
    v_mfma_f32_16x16x32_bf16 v[60:63], v[164:167], v[212:215], v[60:63]
    ds_read_b64_tr_b16 v[134:135], v7 offset:9216
    ds_read_b64_tr_b16 v[136:137], v8 offset:8192
    s_add_u32 m0, s69, 18432
    v_mfma_f32_16x16x32_bf16 v[92:95], v[164:167], v[216:219], v[92:95]
    ds_read_b64_tr_b16 v[138:139], v8 offset:9216
    buffer_load_dwordx4 v2, s[40:43], s63 offen lds
    v_mfma_f32_16x16x32_bf16 v[64:67], v[168:171], v[212:215], v[64:67]
    ds_read_b64_tr_b16 v[140:141], v9 offset:8192
    ds_read_b64_tr_b16 v[142:143], v9 offset:9216
    s_add_u32 m0, s69, 22528
    v_mfma_f32_16x16x32_bf16 v[96:99], v[168:171], v[216:219], v[96:99]
    ds_read_b64_tr_b16 v[144:145], v10 offset:8192
    buffer_load_dwordx4 v2, s[40:43], s64 offen lds
    v_mfma_f32_16x16x32_bf16 v[68:71], v[212:215], v[172:175], v[68:71]
    ds_read_b64_tr_b16 v[146:147], v10 offset:9216
    ds_read_b64_tr_b16 v[148:149], v11 offset:8192
    s_add_u32 m0, s69, 26624
    v_mfma_f32_16x16x32_bf16 v[100:103], v[216:219], v[172:175], v[100:103]
    ds_read_b64_tr_b16 v[150:151], v11 offset:9216
    buffer_load_dwordx4 v2, s[40:43], s65 offen lds
    v_mfma_f32_16x16x32_bf16 v[72:75], v[212:215], v[176:179], v[72:75]
    ds_read_b128 v[208:211], v12 offset:36864
    ds_read_b64_tr_b16 v[184:185], v16 offset:8192
    s_add_u32 m0, s69, 30720
    v_mfma_f32_16x16x32_bf16 v[104:107], v[216:219], v[176:179], v[104:107]
    ds_read_b64_tr_b16 v[186:187], v16 offset:9216
    buffer_load_dwordx4 v2, s[40:43], s66 offen lds
    v_mfma_f32_16x16x32_bf16 v[76:79], v[212:215], v[180:183], v[76:79]
    ds_read_b64_tr_b16 v[188:189], v17 offset:8192
    v_mfma_f32_16x16x32_bf16 v[108:111], v[216:219], v[180:183], v[108:111]
    ds_read_b64_tr_b16 v[190:191], v17 offset:9216
    s_mov_b32 m0, s71
    v_mfma_f32_16x16x32_bf16 v[112:115], v[192:195], v[220:223], v[112:115]
    buffer_load_dwordx4 v2, s[40:43], s67 offen lds
    v_mfma_f32_16x16x32_bf16 v[116:119], v[220:223], v[196:199], v[116:119]
    s_sub_u32 s80, s80, 1
    s_cselect_b32 s73, s7, s56
    v_add_u32 v2, s73, v2
    s_waitcnt vmcnt(7) lgkmcnt(0)
    s_barrier
    v_mfma_f32_16x16x32_bf16 v[48:51], v[120:123], v[200:203], v[48:51]
    ds_read_b128 v[212:215], v19 offset:36864
    ds_read_b128 v[216:219], v19 offset:38912
    s_add_u32 m0, s68, 8192
    v_mfma_f32_16x16x32_bf16 v[80:83], v[120:123], v[204:207], v[80:83]
    ds_read_b64_tr_b16 v[152:153], v4 offset:16384
    buffer_load_dwordx4 v1, s[44:47], s61 offen lds
    v_mfma_f32_16x16x32_bf16 v[52:55], v[124:127], v[200:203], v[52:55]
    ds_read_b64_tr_b16 v[154:155], v4 offset:17408
    ds_read_b64_tr_b16 v[156:157], v5 offset:16384
    s_add_u32 m0, s68, 12288
    v_mfma_f32_16x16x32_bf16 v[84:87], v[124:127], v[204:207], v[84:87]
    ds_read_b64_tr_b16 v[158:159], v5 offset:17408
    buffer_load_dwordx4 v1, s[44:47], s62 offen lds
    v_mfma_f32_16x16x32_bf16 v[56:59], v[128:131], v[200:203], v[56:59]
    ds_read_b64_tr_b16 v[160:161], v6 offset:16384
    ds_read_b64_tr_b16 v[162:163], v6 offset:17408
    v_mfma_f32_16x16x32_bf16 v[88:91], v[128:131], v[204:207], v[88:91]
    ds_read_b64_tr_b16 v[164:165], v7 offset:16384
    s_sub_u32 s81, s81, 1
    s_cselect_b32 s73, s101, s100
    v_add_u32 v1, s73, v1
    v_mfma_f32_16x16x32_bf16 v[60:63], v[132:135], v[200:203], v[60:63]
    ds_read_b64_tr_b16 v[166:167], v7 offset:17408
    ds_read_b64_tr_b16 v[168:169], v8 offset:16384
    v_mfma_f32_16x16x32_bf16 v[92:95], v[132:135], v[204:207], v[92:95]
    ds_read_b64_tr_b16 v[170:171], v8 offset:17408
    ds_read_b64_tr_b16 v[172:173], v9 offset:16384
    v_mfma_f32_16x16x32_bf16 v[64:67], v[136:139], v[200:203], v[64:67]
    ds_read_b64_tr_b16 v[174:175], v9 offset:17408
    v_mfma_f32_16x16x32_bf16 v[96:99], v[136:139], v[204:207], v[96:99]
    ds_read_b64_tr_b16 v[176:177], v10 offset:16384
    v_mfma_f32_16x16x32_bf16 v[68:71], v[200:203], v[140:143], v[68:71]
    ds_read_b64_tr_b16 v[178:179], v10 offset:17408
    v_mfma_f32_16x16x32_bf16 v[100:103], v[204:207], v[140:143], v[100:103]
    ds_read_b64_tr_b16 v[180:181], v11 offset:16384
    v_mfma_f32_16x16x32_bf16 v[72:75], v[200:203], v[144:147], v[72:75]
    ds_read_b64_tr_b16 v[182:183], v11 offset:17408
    v_mfma_f32_16x16x32_bf16 v[104:107], v[204:207], v[144:147], v[104:107]
    ds_read_b128 v[220:223], v13 offset:36864
    v_mfma_f32_16x16x32_bf16 v[76:79], v[200:203], v[148:151], v[76:79]
    ds_read_b64_tr_b16 v[192:193], v16 offset:16384
    v_mfma_f32_16x16x32_bf16 v[108:111], v[204:207], v[148:151], v[108:111]
    ds_read_b64_tr_b16 v[194:195], v16 offset:17408
    v_mfma_f32_16x16x32_bf16 v[112:115], v[184:187], v[208:211], v[112:115]
    ds_read_b64_tr_b16 v[196:197], v17 offset:16384
    v_mfma_f32_16x16x32_bf16 v[116:119], v[208:211], v[188:191], v[116:119]
    ds_read_b64_tr_b16 v[198:199], v17 offset:17408
    s_waitcnt vmcnt(7) lgkmcnt(0)
    s_barrier
    v_mfma_f32_16x16x32_bf16 v[48:51], v[152:155], v[212:215], v[48:51]
    ds_read_b128 v[200:203], v18 offset:0
    ds_read_b128 v[204:207], v18 offset:2048
    s_add_u32 m0, s68, 16384
    v_mfma_f32_16x16x32_bf16 v[80:83], v[152:155], v[216:219], v[80:83]
    ds_read_b64_tr_b16 v[120:121], v4 offset:0
    buffer_load_dwordx4 v1, s[44:47], s61 offen lds
    v_mfma_f32_16x16x32_bf16 v[52:55], v[156:159], v[212:215], v[52:55]
    ds_read_b64_tr_b16 v[122:123], v4 offset:1024
    ds_read_b64_tr_b16 v[124:125], v5 offset:0
    s_add_u32 m0, s68, 20480
    v_mfma_f32_16x16x32_bf16 v[84:87], v[156:159], v[216:219], v[84:87]
    ds_read_b64_tr_b16 v[126:127], v5 offset:1024
    buffer_load_dwordx4 v1, s[44:47], s62 offen lds
    v_mfma_f32_16x16x32_bf16 v[56:59], v[160:163], v[212:215], v[56:59]
    ds_read_b64_tr_b16 v[128:129], v6 offset:0
    ds_read_b64_tr_b16 v[130:131], v6 offset:1024
    v_mfma_f32_16x16x32_bf16 v[88:91], v[160:163], v[216:219], v[88:91]
    ds_read_b64_tr_b16 v[132:133], v7 offset:0
    s_sub_u32 s81, s81, 1
    s_cselect_b32 s73, s101, s100
    v_add_u32 v1, s73, v1
    v_mfma_f32_16x16x32_bf16 v[60:63], v[164:167], v[212:215], v[60:63]
    ds_read_b64_tr_b16 v[134:135], v7 offset:1024
    ds_read_b64_tr_b16 v[136:137], v8 offset:0
    s_add_u32 m0, s69, 36864
    v_mfma_f32_16x16x32_bf16 v[92:95], v[164:167], v[216:219], v[92:95]
    ds_read_b64_tr_b16 v[138:139], v8 offset:1024
    buffer_load_dwordx4 v2, s[40:43], s63 offen lds
    v_mfma_f32_16x16x32_bf16 v[64:67], v[168:171], v[212:215], v[64:67]
    ds_read_b64_tr_b16 v[140:141], v9 offset:0
    ds_read_b64_tr_b16 v[142:143], v9 offset:1024
    s_add_u32 m0, s69, 40960
    v_mfma_f32_16x16x32_bf16 v[96:99], v[168:171], v[216:219], v[96:99]
    ds_read_b64_tr_b16 v[144:145], v10 offset:0
    buffer_load_dwordx4 v2, s[40:43], s64 offen lds
    v_mfma_f32_16x16x32_bf16 v[68:71], v[212:215], v[172:175], v[68:71]
    ds_read_b64_tr_b16 v[146:147], v10 offset:1024
    ds_read_b64_tr_b16 v[148:149], v11 offset:0
    s_add_u32 m0, s69, 45056
    v_mfma_f32_16x16x32_bf16 v[100:103], v[216:219], v[172:175], v[100:103]
    ds_read_b64_tr_b16 v[150:151], v11 offset:1024
    buffer_load_dwordx4 v2, s[40:43], s65 offen lds
    v_mfma_f32_16x16x32_bf16 v[72:75], v[212:215], v[176:179], v[72:75]
    ds_read_b128 v[208:211], v12 offset:0
    ds_read_b64_tr_b16 v[184:185], v16 offset:0
    s_add_u32 m0, s69, 49152
    v_mfma_f32_16x16x32_bf16 v[104:107], v[216:219], v[176:179], v[104:107]
    ds_read_b64_tr_b16 v[186:187], v16 offset:1024
    buffer_load_dwordx4 v2, s[40:43], s66 offen lds
    v_mfma_f32_16x16x32_bf16 v[76:79], v[212:215], v[180:183], v[76:79]
    ds_read_b64_tr_b16 v[188:189], v17 offset:0
    v_mfma_f32_16x16x32_bf16 v[108:111], v[216:219], v[180:183], v[108:111]
    ds_read_b64_tr_b16 v[190:191], v17 offset:1024
    s_mov_b32 m0, s72
    v_mfma_f32_16x16x32_bf16 v[112:115], v[192:195], v[220:223], v[112:115]
    buffer_load_dwordx4 v2, s[40:43], s67 offen lds
    v_mfma_f32_16x16x32_bf16 v[116:119], v[220:223], v[196:199], v[116:119]
    s_sub_u32 s80, s80, 1
    s_cselect_b32 s73, s7, s56
    v_add_u32 v2, s73, v2
    s_add_u32 s74, s74, 1
    s_cmp_lt_u32 s74, 2
    s_cbranch_scc1 L_a1loop_10
    s_waitcnt vmcnt(7) lgkmcnt(0)
    s_barrier
    v_mfma_f32_16x16x32_bf16 v[48:51], v[120:123], v[200:203], v[48:51]
    ds_read_b128 v[212:215], v19 offset:0
    ds_read_b128 v[216:219], v19 offset:2048
    s_add_u32 m0, s68, 0
    v_mfma_f32_16x16x32_bf16 v[80:83], v[120:123], v[204:207], v[80:83]
    ds_read_b64_tr_b16 v[152:153], v4 offset:8192
    buffer_load_dwordx4 v1, s[44:47], s61 offen lds
    v_mfma_f32_16x16x32_bf16 v[52:55], v[124:127], v[200:203], v[52:55]
    ds_read_b64_tr_b16 v[154:155], v4 offset:9216
    ds_read_b64_tr_b16 v[156:157], v5 offset:8192
    s_add_u32 m0, s68, 4096
    v_mfma_f32_16x16x32_bf16 v[84:87], v[124:127], v[204:207], v[84:87]
    ds_read_b64_tr_b16 v[158:159], v5 offset:9216
    buffer_load_dwordx4 v1, s[44:47], s62 offen lds
    v_mfma_f32_16x16x32_bf16 v[56:59], v[128:131], v[200:203], v[56:59]
    ds_read_b64_tr_b16 v[160:161], v6 offset:8192
    ds_read_b64_tr_b16 v[162:163], v6 offset:9216
    v_mfma_f32_16x16x32_bf16 v[88:91], v[128:131], v[204:207], v[88:91]
    ds_read_b64_tr_b16 v[164:165], v7 offset:8192
    s_sub_u32 s81, s81, 1
    s_cselect_b32 s73, s101, s100
    v_add_u32 v1, s73, v1
    v_mfma_f32_16x16x32_bf16 v[60:63], v[132:135], v[200:203], v[60:63]
    ds_read_b64_tr_b16 v[166:167], v7 offset:9216
    ds_read_b64_tr_b16 v[168:169], v8 offset:8192
    v_mfma_f32_16x16x32_bf16 v[92:95], v[132:135], v[204:207], v[92:95]
    ds_read_b64_tr_b16 v[170:171], v8 offset:9216
    ds_read_b64_tr_b16 v[172:173], v9 offset:8192
    v_mfma_f32_16x16x32_bf16 v[64:67], v[136:139], v[200:203], v[64:67]
    ds_read_b64_tr_b16 v[174:175], v9 offset:9216
    v_mfma_f32_16x16x32_bf16 v[96:99], v[136:139], v[204:207], v[96:99]
    ds_read_b64_tr_b16 v[176:177], v10 offset:8192
    v_mfma_f32_16x16x32_bf16 v[68:71], v[200:203], v[140:143], v[68:71]
    ds_read_b64_tr_b16 v[178:179], v10 offset:9216
    v_mfma_f32_16x16x32_bf16 v[100:103], v[204:207], v[140:143], v[100:103]
    ds_read_b64_tr_b16 v[180:181], v11 offset:8192
    v_mfma_f32_16x16x32_bf16 v[72:75], v[200:203], v[144:147], v[72:75]
    ds_read_b64_tr_b16 v[182:183], v11 offset:9216
    v_mfma_f32_16x16x32_bf16 v[104:107], v[204:207], v[144:147], v[104:107]
    ds_read_b128 v[220:223], v13 offset:0
    v_mfma_f32_16x16x32_bf16 v[76:79], v[200:203], v[148:151], v[76:79]
    ds_read_b64_tr_b16 v[192:193], v16 offset:8192
    v_mfma_f32_16x16x32_bf16 v[108:111], v[204:207], v[148:151], v[108:111]
    ds_read_b64_tr_b16 v[194:195], v16 offset:9216
    v_mfma_f32_16x16x32_bf16 v[112:115], v[184:187], v[208:211], v[112:115]
    ds_read_b64_tr_b16 v[196:197], v17 offset:8192
    v_mfma_f32_16x16x32_bf16 v[116:119], v[208:211], v[188:191], v[116:119]
    ds_read_b64_tr_b16 v[198:199], v17 offset:9216
    s_waitcnt vmcnt(7) lgkmcnt(0)
    s_barrier
    v_mfma_f32_16x16x32_bf16 v[48:51], v[152:155], v[212:215], v[48:51]
    ds_read_b128 v[200:203], v18 offset:18432
    ds_read_b128 v[204:207], v18 offset:20480
    s_add_u32 m0, s68, 8192
    v_mfma_f32_16x16x32_bf16 v[80:83], v[152:155], v[216:219], v[80:83]
    ds_read_b64_tr_b16 v[120:121], v4 offset:16384
    buffer_load_dwordx4 v1, s[44:47], s61 offen lds
    v_mfma_f32_16x16x32_bf16 v[52:55], v[156:159], v[212:215], v[52:55]
    ds_read_b64_tr_b16 v[122:123], v4 offset:17408
    ds_read_b64_tr_b16 v[124:125], v5 offset:16384
    s_add_u32 m0, s68, 12288
    v_mfma_f32_16x16x32_bf16 v[84:87], v[156:159], v[216:219], v[84:87]
    ds_read_b64_tr_b16 v[126:127], v5 offset:17408
    buffer_load_dwordx4 v1, s[44:47], s62 offen lds
    v_mfma_f32_16x16x32_bf16 v[56:59], v[160:163], v[212:215], v[56:59]
    ds_read_b64_tr_b16 v[128:129], v6 offset:16384
    ds_read_b64_tr_b16 v[130:131], v6 offset:17408
    v_mfma_f32_16x16x32_bf16 v[88:91], v[160:163], v[216:219], v[88:91]
    ds_read_b64_tr_b16 v[132:133], v7 offset:16384
    s_sub_u32 s81, s81, 1
    s_cselect_b32 s73, s101, s100
    v_add_u32 v1, s73, v1
    v_mfma_f32_16x16x32_bf16 v[60:63], v[164:167], v[212:215], v[60:63]
    ds_read_b64_tr_b16 v[134:135], v7 offset:17408
    ds_read_b64_tr_b16 v[136:137], v8 offset:16384
    s_add_u32 m0, s69, 0
    v_mfma_f32_16x16x32_bf16 v[92:95], v[164:167], v[216:219], v[92:95]
    ds_read_b64_tr_b16 v[138:139], v8 offset:17408
    buffer_load_dwordx4 v2, s[40:43], s63 offen lds
    v_mfma_f32_16x16x32_bf16 v[64:67], v[168:171], v[212:215], v[64:67]
    ds_read_b64_tr_b16 v[140:141], v9 offset:16384
    ds_read_b64_tr_b16 v[142:143], v9 offset:17408
    s_add_u32 m0, s69, 4096
    v_mfma_f32_16x16x32_bf16 v[96:99], v[168:171], v[216:219], v[96:99]
    ds_read_b64_tr_b16 v[144:145], v10 offset:16384
    buffer_load_dwordx4 v2, s[40:43], s64 offen lds
    v_mfma_f32_16x16x32_bf16 v[68:71], v[212:215], v[172:175], v[68:71]
    ds_read_b64_tr_b16 v[146:147], v10 offset:17408
    ds_read_b64_tr_b16 v[148:149], v11 offset:16384
    s_add_u32 m0, s69, 8192
    v_mfma_f32_16x16x32_bf16 v[100:103], v[216:219], v[172:175], v[100:103]
    ds_read_b64_tr_b16 v[150:151], v11 offset:17408
    buffer_load_dwordx4 v2, s[40:43], s65 offen lds
    v_mfma_f32_16x16x32_bf16 v[72:75], v[212:215], v[176:179], v[72:75]
    ds_read_b128 v[208:211], v12 offset:18432
    ds_read_b64_tr_b16 v[184:185], v16 offset:16384
    s_add_u32 m0, s69, 12288
    v_mfma_f32_16x16x32_bf16 v[104:107], v[216:219], v[176:179], v[104:107]
    ds_read_b64_tr_b16 v[186:187], v16 offset:17408
    buffer_load_dwordx4 v2, s[40:43], s66 offen lds
    v_mfma_f32_16x16x32_bf16 v[76:79], v[212:215], v[180:183], v[76:79]
    ds_read_b64_tr_b16 v[188:189], v17 offset:16384
    v_mfma_f32_16x16x32_bf16 v[108:111], v[216:219], v[180:183], v[108:111]
    ds_read_b64_tr_b16 v[190:191], v17 offset:17408
    s_mov_b32 m0, s70
    v_mfma_f32_16x16x32_bf16 v[112:115], v[192:195], v[220:223], v[112:115]
    buffer_load_dwordx4 v2, s[40:43], s67 offen lds
    v_mfma_f32_16x16x32_bf16 v[116:119], v[220:223], v[196:199], v[116:119]
    s_sub_u32 s80, s80, 1
    s_cselect_b32 s73, s7, s56
    v_add_u32 v2, s73, v2
    s_waitcnt vmcnt(7) lgkmcnt(0)
    s_barrier
    v_mfma_f32_16x16x32_bf16 v[48:51], v[120:123], v[200:203], v[48:51]
    ds_read_b128 v[212:215], v19 offset:18432
    ds_read_b128 v[216:219], v19 offset:20480
    s_add_u32 m0, s68, 16384
    v_mfma_f32_16x16x32_bf16 v[80:83], v[120:123], v[204:207], v[80:83]
    ds_read_b64_tr_b16 v[152:153], v4 offset:0
    buffer_load_dwordx4 v1, s[44:47], s61 offen lds
    v_mfma_f32_16x16x32_bf16 v[52:55], v[124:127], v[200:203], v[52:55]
    ds_read_b64_tr_b16 v[154:155], v4 offset:1024
    ds_read_b64_tr_b16 v[156:157], v5 offset:0
    s_add_u32 m0, s68, 20480
    v_mfma_f32_16x16x32_bf16 v[84:87], v[124:127], v[204:207], v[84:87]
    ds_read_b64_tr_b16 v[158:159], v5 offset:1024
    buffer_load_dwordx4 v1, s[44:47], s62 offen lds
    v_mfma_f32_16x16x32_bf16 v[56:59], v[128:131], v[200:203], v[56:59]
    ds_read_b64_tr_b16 v[160:161], v6 offset:0
    ds_read_b64_tr_b16 v[162:163], v6 offset:1024
    v_mfma_f32_16x16x32_bf16 v[88:91], v[128:131], v[204:207], v[88:91]
    ds_read_b64_tr_b16 v[164:165], v7 offset:0
    s_sub_u32 s81, s81, 1
    s_cselect_b32 s73, s101, s100
    v_add_u32 v1, s73, v1
    v_mfma_f32_16x16x32_bf16 v[60:63], v[132:135], v[200:203], v[60:63]
    ds_read_b64_tr_b16 v[166:167], v7 offset:1024
    ds_read_b64_tr_b16 v[168:169], v8 offset:0
    v_mfma_f32_16x16x32_bf16 v[92:95], v[132:135], v[204:207], v[92:95]
    ds_read_b64_tr_b16 v[170:171], v8 offset:1024
    ds_read_b64_tr_b16 v[172:173], v9 offset:0
    v_mfma_f32_16x16x32_bf16 v[64:67], v[136:139], v[200:203], v[64:67]
    ds_read_b64_tr_b16 v[174:175], v9 offset:1024
    v_mfma_f32_16x16x32_bf16 v[96:99], v[136:139], v[204:207], v[96:99]
    ds_read_b64_tr_b16 v[176:177], v10 offset:0
    v_mfma_f32_16x16x32_bf16 v[68:71], v[200:203], v[140:143], v[68:71]
    ds_read_b64_tr_b16 v[178:179], v10 offset:1024
    v_mfma_f32_16x16x32_bf16 v[100:103], v[204:207], v[140:143], v[100:103]
    ds_read_b64_tr_b16 v[180:181], v11 offset:0
    v_mfma_f32_16x16x32_bf16 v[72:75], v[200:203], v[144:147], v[72:75]
    ds_read_b64_tr_b16 v[182:183], v11 offset:1024
    v_mfma_f32_16x16x32_bf16 v[104:107], v[204:207], v[144:147], v[104:107]
    ds_read_b128 v[220:223], v13 offset:18432
    v_mfma_f32_16x16x32_bf16 v[76:79], v[200:203], v[148:151], v[76:79]
    ds_read_b64_tr_b16 v[192:193], v16 offset:0
    v_mfma_f32_16x16x32_bf16 v[108:111], v[204:207], v[148:151], v[108:111]
    ds_read_b64_tr_b16 v[194:195], v16 offset:1024
    v_mfma_f32_16x16x32_bf16 v[112:115], v[184:187], v[208:211], v[112:115]
    ds_read_b64_tr_b16 v[196:197], v17 offset:0
    v_mfma_f32_16x16x32_bf16 v[116:119], v[208:211], v[188:191], v[116:119]
    ds_read_b64_tr_b16 v[198:199], v17 offset:1024
    s_waitcnt vmcnt(7) lgkmcnt(0)
    s_barrier
    v_mfma_f32_16x16x32_bf16 v[48:51], v[152:155], v[212:215], v[48:51]
    ds_read_b128 v[200:203], v18 offset:36864
    ds_read_b128 v[204:207], v18 offset:38912
    s_add_u32 m0, s68, 0
    v_mfma_f32_16x16x32_bf16 v[80:83], v[152:155], v[216:219], v[80:83]
    ds_read_b64_tr_b16 v[120:121], v4 offset:8192
    buffer_load_dwordx4 v1, s[44:47], s61 offen lds
    v_mfma_f32_16x16x32_bf16 v[52:55], v[156:159], v[212:215], v[52:55]
    ds_read_b64_tr_b16 v[122:123], v4 offset:9216
    ds_read_b64_tr_b16 v[124:125], v5 offset:8192
    s_add_u32 m0, s68, 4096
    v_mfma_f32_16x16x32_bf16 v[84:87], v[156:159], v[216:219], v[84:87]
    ds_read_b64_tr_b16 v[126:127], v5 offset:9216
    buffer_load_dwordx4 v1, s[44:47], s62 offen lds
    v_mfma_f32_16x16x32_bf16 v[56:59], v[160:163], v[212:215], v[56:59]
    ds_read_b64_tr_b16 v[128:129], v6 offset:8192
    ds_read_b64_tr_b16 v[130:131], v6 offset:9216
    v_mfma_f32_16x16x32_bf16 v[88:91], v[160:163], v[216:219], v[88:91]
    ds_read_b64_tr_b16 v[132:133], v7 offset:8192
    s_sub_u32 s81, s81, 1
    s_cselect_b32 s73, s101, s100
    v_add_u32 v1, s73, v1
    v_mfma_f32_16x16x32_bf16 v[60:63], v[164:167], v[212:215], v[60:63]
    ds_read_b64_tr_b16 v[134:135], v7 offset:9216
    ds_read_b64_tr_b16 v[136:137], v8 offset:8192
    v_mfma_f32_16x16x32_bf16 v[92:95], v[164:167], v[216:219], v[92:95]
    ds_read_b64_tr_b16 v[138:139], v8 offset:9216
    ds_read_b64_tr_b16 v[140:141], v9 offset:8192
    v_mfma_f32_16x16x32_bf16 v[64:67], v[168:171], v[212:215], v[64:67]
    ds_read_b64_tr_b16 v[142:143], v9 offset:9216
    v_mfma_f32_16x16x32_bf16 v[96:99], v[168:171], v[216:219], v[96:99]
    ds_read_b64_tr_b16 v[144:145], v10 offset:8192
    v_mfma_f32_16x16x32_bf16 v[68:71], v[212:215], v[172:175], v[68:71]
    ds_read_b64_tr_b16 v[146:147], v10 offset:9216
    v_mfma_f32_16x16x32_bf16 v[100:103], v[216:219], v[172:175], v[100:103]
    ds_read_b64_tr_b16 v[148:149], v11 offset:8192
    v_mfma_f32_16x16x32_bf16 v[72:75], v[212:215], v[176:179], v[72:75]
    ds_read_b64_tr_b16 v[150:151], v11 offset:9216
    v_mfma_f32_16x16x32_bf16 v[104:107], v[216:219], v[176:179], v[104:107]
    ds_read_b128 v[208:211], v12 offset:36864
    v_mfma_f32_16x16x32_bf16 v[76:79], v[212:215], v[180:183], v[76:79]
    ds_read_b64_tr_b16 v[184:185], v16 offset:8192
    v_mfma_f32_16x16x32_bf16 v[108:111], v[216:219], v[180:183], v[108:111]
    ds_read_b64_tr_b16 v[186:187], v16 offset:9216
    v_mfma_f32_16x16x32_bf16 v[112:115], v[192:195], v[220:223], v[112:115]
    ds_read_b64_tr_b16 v[188:189], v17 offset:8192
    v_mfma_f32_16x16x32_bf16 v[116:119], v[220:223], v[196:199], v[116:119]
    ds_read_b64_tr_b16 v[190:191], v17 offset:9216
    s_waitcnt vmcnt(2) lgkmcnt(0)
    s_barrier
    v_mfma_f32_16x16x32_bf16 v[48:51], v[120:123], v[200:203], v[48:51]
    ds_read_b128 v[212:215], v19 offset:36864
    ds_read_b128 v[216:219], v19 offset:38912
    s_add_u32 m0, s68, 8192
    v_mfma_f32_16x16x32_bf16 v[80:83], v[120:123], v[204:207], v[80:83]
    ds_read_b64_tr_b16 v[152:153], v4 offset:16384
    buffer_load_dwordx4 v1, s[44:47], s61 offen lds
    v_mfma_f32_16x16x32_bf16 v[52:55], v[124:127], v[200:203], v[52:55]
    ds_read_b64_tr_b16 v[154:155], v4 offset:17408
    ds_read_b64_tr_b16 v[156:157], v5 offset:16384
    s_add_u32 m0, s68, 12288
    v_mfma_f32_16x16x32_bf16 v[84:87], v[124:127], v[204:207], v[84:87]
    ds_read_b64_tr_b16 v[158:159], v5 offset:17408
    buffer_load_dwordx4 v1, s[44:47], s62 offen lds
    v_mfma_f32_16x16x32_bf16 v[56:59], v[128:131], v[200:203], v[56:59]
    ds_read_b64_tr_b16 v[160:161], v6 offset:16384
    ds_read_b64_tr_b16 v[162:163], v6 offset:17408
    v_mfma_f32_16x16x32_bf16 v[88:91], v[128:131], v[204:207], v[88:91]
    ds_read_b64_tr_b16 v[164:165], v7 offset:16384
    s_sub_u32 s81, s81, 1
    s_cselect_b32 s73, s101, s100
    v_add_u32 v1, s73, v1
    v_mfma_f32_16x16x32_bf16 v[60:63], v[132:135], v[200:203], v[60:63]
    ds_read_b64_tr_b16 v[166:167], v7 offset:17408
    ds_read_b64_tr_b16 v[168:169], v8 offset:16384
    v_mfma_f32_16x16x32_bf16 v[92:95], v[132:135], v[204:207], v[92:95]
    ds_read_b64_tr_b16 v[170:171], v8 offset:17408
    ds_read_b64_tr_b16 v[172:173], v9 offset:16384
    v_mfma_f32_16x16x32_bf16 v[64:67], v[136:139], v[200:203], v[64:67]
    ds_read_b64_tr_b16 v[174:175], v9 offset:17408
    v_mfma_f32_16x16x32_bf16 v[96:99], v[136:139], v[204:207], v[96:99]
    ds_read_b64_tr_b16 v[176:177], v10 offset:16384
    v_mfma_f32_16x16x32_bf16 v[68:71], v[200:203], v[140:143], v[68:71]
    ds_read_b64_tr_b16 v[178:179], v10 offset:17408
    v_mfma_f32_16x16x32_bf16 v[100:103], v[204:207], v[140:143], v[100:103]
    ds_read_b64_tr_b16 v[180:181], v11 offset:16384
    v_mfma_f32_16x16x32_bf16 v[72:75], v[200:203], v[144:147], v[72:75]
    ds_read_b64_tr_b16 v[182:183], v11 offset:17408
    v_mfma_f32_16x16x32_bf16 v[104:107], v[204:207], v[144:147], v[104:107]
    ds_read_b128 v[220:223], v13 offset:36864
    v_mfma_f32_16x16x32_bf16 v[76:79], v[200:203], v[148:151], v[76:79]
    ds_read_b64_tr_b16 v[192:193], v16 offset:16384
    v_mfma_f32_16x16x32_bf16 v[108:111], v[204:207], v[148:151], v[108:111]
    ds_read_b64_tr_b16 v[194:195], v16 offset:17408
    v_mfma_f32_16x16x32_bf16 v[112:115], v[184:187], v[208:211], v[112:115]
    ds_read_b64_tr_b16 v[196:197], v17 offset:16384
    v_mfma_f32_16x16x32_bf16 v[116:119], v[208:211], v[188:191], v[116:119]
    ds_read_b64_tr_b16 v[198:199], v17 offset:17408
    s_waitcnt vmcnt(2) lgkmcnt(0)
    s_barrier
    v_mfma_f32_16x16x32_bf16 v[48:51], v[152:155], v[212:215], v[48:51]
    ds_read_b128 v[200:203], v18 offset:0
    ds_read_b128 v[204:207], v18 offset:2048
    v_mfma_f32_16x16x32_bf16 v[80:83], v[152:155], v[216:219], v[80:83]
    ds_read_b64_tr_b16 v[120:121], v4 offset:0
    ds_read_b64_tr_b16 v[122:123], v4 offset:1024
    v_mfma_f32_16x16x32_bf16 v[52:55], v[156:159], v[212:215], v[52:55]
    ds_read_b64_tr_b16 v[124:125], v5 offset:0
    ds_read_b64_tr_b16 v[126:127], v5 offset:1024
    v_mfma_f32_16x16x32_bf16 v[84:87], v[156:159], v[216:219], v[84:87]
    ds_read_b64_tr_b16 v[128:129], v6 offset:0
    ds_read_b64_tr_b16 v[130:131], v6 offset:1024
    v_mfma_f32_16x16x32_bf16 v[56:59], v[160:163], v[212:215], v[56:59]
    ds_read_b64_tr_b16 v[132:133], v7 offset:0
    ds_read_b64_tr_b16 v[134:135], v7 offset:1024
    v_mfma_f32_16x16x32_bf16 v[88:91], v[160:163], v[216:219], v[88:91]
    ds_read_b64_tr_b16 v[136:137], v8 offset:0
    v_mfma_f32_16x16x32_bf16 v[60:63], v[164:167], v[212:215], v[60:63]
    ds_read_b64_tr_b16 v[138:139], v8 offset:1024
    v_mfma_f32_16x16x32_bf16 v[92:95], v[164:167], v[216:219], v[92:95]
    ds_read_b64_tr_b16 v[140:141], v9 offset:0
    v_mfma_f32_16x16x32_bf16 v[64:67], v[168:171], v[212:215], v[64:67]
    ds_read_b64_tr_b16 v[142:143], v9 offset:1024
    v_mfma_f32_16x16x32_bf16 v[96:99], v[168:171], v[216:219], v[96:99]
    ds_read_b64_tr_b16 v[144:145], v10 offset:0
    v_mfma_f32_16x16x32_bf16 v[68:71], v[212:215], v[172:175], v[68:71]
    ds_read_b64_tr_b16 v[146:147], v10 offset:1024
    v_mfma_f32_16x16x32_bf16 v[100:103], v[216:219], v[172:175], v[100:103]
    ds_read_b64_tr_b16 v[148:149], v11 offset:0
    v_mfma_f32_16x16x32_bf16 v[72:75], v[212:215], v[176:179], v[72:75]
    ds_read_b64_tr_b16 v[150:151], v11 offset:1024
    v_mfma_f32_16x16x32_bf16 v[104:107], v[216:219], v[176:179], v[104:107]
    ds_read_b128 v[208:211], v12 offset:0
    v_mfma_f32_16x16x32_bf16 v[76:79], v[212:215], v[180:183], v[76:79]
    ds_read_b64_tr_b16 v[184:185], v16 offset:0
    v_mfma_f32_16x16x32_bf16 v[108:111], v[216:219], v[180:183], v[108:111]
    ds_read_b64_tr_b16 v[186:187], v16 offset:1024
    v_mfma_f32_16x16x32_bf16 v[112:115], v[192:195], v[220:223], v[112:115]
    ds_read_b64_tr_b16 v[188:189], v17 offset:0
    v_mfma_f32_16x16x32_bf16 v[116:119], v[220:223], v[196:199], v[116:119]
    ds_read_b64_tr_b16 v[190:191], v17 offset:1024
    s_sub_u32 s57, s2, 160
    s_lshr_b32 s58, s57, 3
    s_lshl_b32 s59, s58, 2
    s_add_u32 s59, s59, s3
    v_mul_u32_u24 v20, 52, v0
    v_lshrrev_b32 v20, 8, v20
    v_mul_u32_u24 v21, 5, v20
    v_sub_u32 v21, v0, v21
    v_mul_u32_u24 v20, 48, v20
    v_add_u32 v20, s59, v20
    v_mul_u32_u24 v22, 1280, v20
    v_lshl_add_u32 v22, v21, 7, v22
    s_and_b32 s57, s57, 1
    s_mul_i32 s57, s57, 640
    v_add_u32 v22, s57, v22
    s_cmp_lt_u32 s58, 12
    s_cselect_b32 s58, 60, 0
    v_mov_b32 v23, 0x80000000
    v_cmp_gt_u32 vcc, s58, v0
    s_nop 1
    v_cndmask_b32 v22, v23, v22, vcc
    s_mov_b32 s40, s20
    s_mov_b32 s41, s21
    s_mov_b32 s42, 0xc8000
    s_mov_b32 s43, 0x20000
    buffer_load_dword v251, v22, s[40:43], 0 offen
    s_mov_b32 s57, 737280
    buffer_load_dword v251, v22, s[40:43], s57 offen
    s_waitcnt vmcnt(2) lgkmcnt(0)
    s_barrier
    v_mfma_f32_16x16x32_bf16 v[48:51], v[120:123], v[200:203], v[48:51]
    ds_read_b128 v[212:215], v19 offset:0
    ds_read_b128 v[216:219], v19 offset:2048
    v_mfma_f32_16x16x32_bf16 v[80:83], v[120:123], v[204:207], v[80:83]
    ds_read_b64_tr_b16 v[152:153], v4 offset:8192
    ds_read_b64_tr_b16 v[154:155], v4 offset:9216
    v_mfma_f32_16x16x32_bf16 v[52:55], v[124:127], v[200:203], v[52:55]
    ds_read_b64_tr_b16 v[156:157], v5 offset:8192
    ds_read_b64_tr_b16 v[158:159], v5 offset:9216
    v_mfma_f32_16x16x32_bf16 v[84:87], v[124:127], v[204:207], v[84:87]
    ds_read_b64_tr_b16 v[160:161], v6 offset:8192
    ds_read_b64_tr_b16 v[162:163], v6 offset:9216
    v_mfma_f32_16x16x32_bf16 v[56:59], v[128:131], v[200:203], v[56:59]
    ds_read_b64_tr_b16 v[164:165], v7 offset:8192
    ds_read_b64_tr_b16 v[166:167], v7 offset:9216
    v_mfma_f32_16x16x32_bf16 v[88:91], v[128:131], v[204:207], v[88:91]
    ds_read_b64_tr_b16 v[168:169], v8 offset:8192
    v_mfma_f32_16x16x32_bf16 v[60:63], v[132:135], v[200:203], v[60:63]
    ds_read_b64_tr_b16 v[170:171], v8 offset:9216
    v_mfma_f32_16x16x32_bf16 v[92:95], v[132:135], v[204:207], v[92:95]
    ds_read_b64_tr_b16 v[172:173], v9 offset:8192
    v_mfma_f32_16x16x32_bf16 v[64:67], v[136:139], v[200:203], v[64:67]
    ds_read_b64_tr_b16 v[174:175], v9 offset:9216
    v_mfma_f32_16x16x32_bf16 v[96:99], v[136:139], v[204:207], v[96:99]
    ds_read_b64_tr_b16 v[176:177], v10 offset:8192
    v_mfma_f32_16x16x32_bf16 v[68:71], v[200:203], v[140:143], v[68:71]
    ds_read_b64_tr_b16 v[178:179], v10 offset:9216
    v_mfma_f32_16x16x32_bf16 v[100:103], v[204:207], v[140:143], v[100:103]
    ds_read_b64_tr_b16 v[180:181], v11 offset:8192
    v_mfma_f32_16x16x32_bf16 v[72:75], v[200:203], v[144:147], v[72:75]
    ds_read_b64_tr_b16 v[182:183], v11 offset:9216
    v_mfma_f32_16x16x32_bf16 v[104:107], v[204:207], v[144:147], v[104:107]
    ds_read_b128 v[220:223], v13 offset:0
    v_mfma_f32_16x16x32_bf16 v[76:79], v[200:203], v[148:151], v[76:79]
    ds_read_b64_tr_b16 v[192:193], v16 offset:8192
    v_mfma_f32_16x16x32_bf16 v[108:111], v[204:207], v[148:151], v[108:111]
    ds_read_b64_tr_b16 v[194:195], v16 offset:9216
    v_mfma_f32_16x16x32_bf16 v[112:115], v[184:187], v[208:211], v[112:115]
    ds_read_b64_tr_b16 v[196:197], v17 offset:8192
    v_mfma_f32_16x16x32_bf16 v[116:119], v[208:211], v[188:191], v[116:119]
    ds_read_b64_tr_b16 v[198:199], v17 offset:9216
    s_waitcnt lgkmcnt(0)
    v_mfma_f32_16x16x32_bf16 v[88:91], v[160:163], v[216:219], v[88:91]
    v_mfma_f32_16x16x32_bf16 v[92:95], v[164:167], v[216:219], v[92:95]
    v_mfma_f32_16x16x32_bf16 v[96:99], v[168:171], v[216:219], v[96:99]
    v_mfma_f32_16x16x32_bf16 v[100:103], v[216:219], v[172:175], v[100:103]
    v_mfma_f32_16x16x32_bf16 v[104:107], v[216:219], v[176:179], v[104:107]
    v_mfma_f32_16x16x32_bf16 v[108:111], v[216:219], v[180:183], v[108:111]
    v_mfma_f32_16x16x32_bf16 v[112:115], v[192:195], v[220:223], v[112:115]
    v_mfma_f32_16x16x32_bf16 v[116:119], v[220:223], v[196:199], v[116:119]
    v_mfma_f32_16x16x32_bf16 v[56:59], v[160:163], v[212:215], v[56:59]
    v_mfma_f32_16x16x32_bf16 v[60:63], v[164:167], v[212:215], v[60:63]
    v_mfma_f32_16x16x32_bf16 v[64:67], v[168:171], v[212:215], v[64:67]
    v_mfma_f32_16x16x32_bf16 v[68:71], v[212:215], v[172:175], v[68:71]
    v_mfma_f32_16x16x32_bf16 v[72:75], v[212:215], v[176:179], v[72:75]
    v_mfma_f32_16x16x32_bf16 v[76:79], v[212:215], v[180:183], v[76:79]
    v_mfma_f32_16x16x32_bf16 v[48:51], v[152:155], v[212:215], v[48:51]
    v_mfma_f32_16x16x32_bf16 v[80:83], v[152:155], v[216:219], v[80:83]
    v_mfma_f32_16x16x32_bf16 v[52:55], v[156:159], v[212:215], v[52:55]
    v_mfma_f32_16x16x32_bf16 v[84:87], v[156:159], v[216:219], v[84:87]
    v_cvt_pk_bf16_f32 v152, v88, v89
    v_cvt_pk_bf16_f32 v153, v90, v91
    v_cvt_pk_bf16_f32 v156, v92, v93
    v_cvt_pk_bf16_f32 v157, v94, v95
    v_cvt_pk_bf16_f32 v182, v96, v97
    v_cvt_pk_bf16_f32 v183, v98, v99
    ds_write_b64 v26, v[152:153] offset:0
    ds_write_b64 v26, v[156:157] offset:512
    v_cvt_pk_bf16_f32 v164, v100, v101
    v_cvt_pk_bf16_f32 v165, v102, v103
    v_cvt_pk_bf16_f32 v170, v104, v105
    v_cvt_pk_bf16_f32 v171, v106, v107
    ds_write_b64 v26, v[182:183] offset:1024
    v_cvt_pk_bf16_f32 v176, v108, v109
    v_cvt_pk_bf16_f32 v177, v110, v111
    ds_write_b64 v26, v[164:165] offset:1536
    ds_write_b64 v26, v[170:171] offset:2048
    v_cvt_pk_bf16_f32 v184, v112, v113
    v_cvt_pk_bf16_f32 v185, v114, v115
    ds_write_b64 v26, v[176:177] offset:2560
    v_cvt_pk_bf16_f32 v186, v116, v117
    v_cvt_pk_bf16_f32 v187, v118, v119
    ds_write_b64 v27, v[184:185] offset:0
    ds_write_b64 v27, v[186:187] offset:1536
    v_cvt_pk_bf16_f32 v144, v56, v57
    v_cvt_pk_bf16_f32 v145, v58, v59
    v_cvt_pk_bf16_f32 v148, v60, v61
    v_cvt_pk_bf16_f32 v149, v62, v63
    v_cvt_pk_bf16_f32 v180, v64, v65
    v_cvt_pk_bf16_f32 v181, v66, v67
    s_waitcnt lgkmcnt(0)
    s_barrier
    ds_read_b64 v[136:137], v28 offset:0
    ds_read_b64 v[140:141], v28 offset:512
    ds_read_b64 v[178:179], v28 offset:1024
    ds_read_b64 v[160:161], v28 offset:1536
    ds_read_b64 v[166:167], v28 offset:2048
    ds_read_b64 v[172:173], v28 offset:2560
    v_mov_b32 v249, 0
    buffer_load_dword v247, v249, s[8:11], 0 offen sc1
    v_cvt_pk_bf16_f32 v162, v68, v69
    v_cvt_pk_bf16_f32 v163, v70, v71
    v_cvt_pk_bf16_f32 v120, v48, v49
    v_cvt_pk_bf16_f32 v121, v50, v51
    v_cvt_pk_bf16_f32 v128, v80, v81
    v_cvt_pk_bf16_f32 v129, v82, v83
    v_cvt_pk_bf16_f32 v168, v72, v73
    v_cvt_pk_bf16_f32 v169, v74, v75
    v_cvt_pk_bf16_f32 v124, v52, v53
    v_cvt_pk_bf16_f32 v125, v54, v55
    v_cvt_pk_bf16_f32 v132, v84, v85
    v_cvt_pk_bf16_f32 v133, v86, v87
    v_cvt_pk_bf16_f32 v174, v76, v77
    v_cvt_pk_bf16_f32 v175, v78, v79
    v_mov_b32 v146, v180
    v_mov_b32 v154, v182
    v_mov_b32 v147, v181
    v_mov_b32 v155, v183
    v_permlane32_swap_b32 v180, v146
    v_permlane32_swap_b32 v182, v154
    v_permlane32_swap_b32 v181, v147
    v_permlane32_swap_b32 v183, v155
    v_mov_b32 v150, v146
    v_mov_b32 v158, v154
    v_mov_b32 v151, v147
    v_mov_b32 v159, v155
    v_cndmask_b32_e64 v122, 0, v180, s[76:77]
    v_cndmask_b32_e64 v130, 0, v182, s[76:77]
    v_cndmask_b32_e64 v126, 0, v180, s[78:79]
    v_cndmask_b32_e64 v134, 0, v182, s[78:79]
    v_cndmask_b32_e64 v123, 0, v181, s[76:77]
    v_cndmask_b32_e64 v131, 0, v183, s[76:77]
    v_cndmask_b32_e64 v127, 0, v181, s[78:79]
    v_cndmask_b32_e64 v135, 0, v183, s[78:79]
    s_waitcnt lgkmcnt(0)
    v_mfma_f32_16x16x32_bf16 v[52:55], v[144:147], v[120:123], v[32:35]
    v_mfma_f32_16x16x32_bf16 v[68:71], v[148:151], v[124:127], v[32:35]
    v_mfma_f32_16x16x32_bf16 v[84:87], v[152:155], v[128:131], v[32:35]
    v_mfma_f32_16x16x32_bf16 v[100:103], v[156:159], v[132:135], v[32:35]
    v_mfma_f32_16x16x32_bf16 v[80:83], v[144:147], v[128:131], v[36:39]
    v_mfma_f32_16x16x32_bf16 v[96:99], v[148:151], v[132:135], v[36:39]
    v_mov_b32 v138, v178
    v_mov_b32 v139, v179
    s_nop 0
    v_permlane32_swap_b32 v178, v138
    s_nop 0
    v_permlane32_swap_b32 v179, v139
    v_mov_b32 v142, v138
    v_mov_b32 v143, v139
    v_mfma_f32_16x16x32_bf16 v[48:51], v[136:139], v[120:123], v[40:43]
    s_nop 0
    v_mfma_f32_16x16x32_bf16 v[64:67], v[140:143], v[124:127], v[40:43]
    v_max3_f32 v225, v84, v85, v86
    v_max3_f32 v229, v100, v101, v102
    v_max3_f32 v217, v52, v53, v54
    v_max3_f32 v221, v68, v69, v70
    v_max3_f32 v224, v80, v81, v82
    v_max3_f32 v228, v96, v97, v98
    s_nop 0
    v_max3_f32 v216, v48, v49, v50
    s_nop 0
    v_max3_f32 v220, v64, v65, v66
    v_max3_f32 v224, v224, v83, v87
    v_max3_f32 v228, v228, v99, v103
    v_max3_f32 v216, v216, v51, v55
    v_max3_f32 v220, v220, v67, v71
    v_max_f32 v224, v224, v225
    v_max_f32 v228, v228, v229
    v_max_f32 v216, v216, v217
    v_max_f32 v220, v220, v221
    v_mov_b32 v226, v224
    v_mov_b32 v230, v228
    v_mov_b32 v218, v216
    v_mov_b32 v222, v220
    v_permlane32_swap_b32 v224, v226
    v_permlane32_swap_b32 v228, v230
    v_permlane32_swap_b32 v216, v218
    v_permlane32_swap_b32 v220, v222
    v_max_f32 v224, v224, v226
    v_max_f32 v228, v228, v230
    v_max_f32 v216, v216, v218
    v_max_f32 v220, v220, v222
    v_mov_b32 v226, v224
    v_mov_b32 v230, v228
    v_mov_b32 v218, v216
    v_mov_b32 v222, v220
    v_permlane16_swap_b32 v224, v226
    v_permlane16_swap_b32 v228, v230
    v_permlane16_swap_b32 v216, v218
    v_permlane16_swap_b32 v220, v222
    v_max_f32 v224, v224, v226
    v_max_f32 v228, v228, v230
    v_max_f32 v216, v216, v218
    v_max_f32 v220, v220, v222
    v_mul_f32 v224, s75, v224
    v_mul_f32 v228, s75, v228
    v_mul_f32 v216, s75, v216
    v_mul_f32 v220, s75, v220
    v_fma_f32 v80, v80, s75, -v224
    v_fma_f32 v96, v96, s75, -v228
    v_fma_f32 v48, v48, s75, -v216
    v_fma_f32 v64, v64, s75, -v220
    v_fma_f32 v84, v84, s75, -v224
    v_fma_f32 v100, v100, s75, -v228
    v_fma_f32 v52, v52, s75, -v216
    v_fma_f32 v68, v68, s75, -v220
    v_fma_f32 v81, v81, s75, -v224
    v_fma_f32 v97, v97, s75, -v228
    v_fma_f32 v49, v49, s75, -v216
    v_fma_f32 v65, v65, s75, -v220
    v_fma_f32 v85, v85, s75, -v224
    v_fma_f32 v101, v101, s75, -v228
    v_fma_f32 v53, v53, s75, -v216
    v_fma_f32 v69, v69, s75, -v220
    v_fma_f32 v82, v82, s75, -v224
    v_fma_f32 v98, v98, s75, -v228
    v_fma_f32 v50, v50, s75, -v216
    v_fma_f32 v66, v66, s75, -v220
    v_fma_f32 v86, v86, s75, -v224
    v_fma_f32 v102, v102, s75, -v228
    v_fma_f32 v54, v54, s75, -v216
    v_fma_f32 v70, v70, s75, -v220
    v_fma_f32 v83, v83, s75, -v224
    v_fma_f32 v99, v99, s75, -v228
    v_fma_f32 v51, v51, s75, -v216
    v_fma_f32 v67, v67, s75, -v220
    v_fma_f32 v87, v87, s75, -v224
    v_fma_f32 v103, v103, s75, -v228
    v_fma_f32 v55, v55, s75, -v216
    v_fma_f32 v71, v71, s75, -v220
    v_exp_f32 v80, v80
    v_exp_f32 v96, v96
    v_exp_f32 v48, v48
    v_exp_f32 v64, v64
    v_exp_f32 v84, v84
    v_exp_f32 v100, v100
    v_exp_f32 v52, v52
    v_exp_f32 v68, v68
    v_exp_f32 v81, v81
    v_exp_f32 v97, v97
    v_exp_f32 v49, v49
    v_exp_f32 v65, v65
    v_exp_f32 v85, v85
    v_exp_f32 v101, v101
    v_exp_f32 v53, v53
    v_exp_f32 v69, v69
    v_exp_f32 v82, v82
    v_exp_f32 v98, v98
    v_exp_f32 v50, v50
    v_exp_f32 v66, v66
    v_exp_f32 v86, v86
    v_exp_f32 v102, v102
    v_exp_f32 v54, v54
    v_exp_f32 v70, v70
    v_exp_f32 v83, v83
    v_exp_f32 v99, v99
    v_exp_f32 v51, v51
    v_exp_f32 v67, v67
    v_exp_f32 v87, v87
    v_exp_f32 v103, v103
    v_exp_f32 v55, v55
    v_exp_f32 v71, v71
    v_cvt_pk_bf16_f32 v208, v80, v81
    v_cvt_pk_bf16_f32 v212, v96, v97
    v_cvt_pk_bf16_f32 v200, v48, v49
    v_cvt_pk_bf16_f32 v204, v64, v65
    v_cvt_pk_bf16_f32 v209, v82, v83
    v_cvt_pk_bf16_f32 v213, v98, v99
    v_cvt_pk_bf16_f32 v201, v50, v51
    v_cvt_pk_bf16_f32 v205, v66, v67
    v_cvt_pk_bf16_f32 v210, v84, v85
    v_cvt_pk_bf16_f32 v214, v100, v101
    v_cvt_pk_bf16_f32 v202, v52, v53
    v_cvt_pk_bf16_f32 v206, v68, v69
    v_cvt_pk_bf16_f32 v211, v86, v87
    v_cvt_pk_bf16_f32 v215, v102, v103
    v_cvt_pk_bf16_f32 v203, v54, v55
    v_cvt_pk_bf16_f32 v207, v70, v71
    v_mfma_f32_16x16x32_bf16 v[88:91], v[162:165], v[208:211], 0
    v_mfma_f32_16x16x32_bf16 v[104:107], v[168:171], v[212:215], 0
    v_mfma_f32_16x16x32_bf16 v[56:59], v[160:163], v[200:203], 0
    v_mfma_f32_16x16x32_bf16 v[72:75], v[166:169], v[204:207], 0
    v_mfma_f32_16x16x32_bf16 v[92:95], v[174:177], v[208:211], 0
    v_mfma_f32_16x16x32_bf16 v[108:111], v[174:177], v[212:215], 0
    v_mfma_f32_16x16x32_bf16 v[60:63], v[172:175], v[200:203], 0
    v_mfma_f32_16x16x32_bf16 v[76:79], v[172:175], v[204:207], 0
    v_mfma_f32_16x16x32_bf16 v[80:83], v[44:47], v[208:211], 0
    v_mfma_f32_16x16x32_bf16 v[96:99], v[44:47], v[212:215], 0
    v_mfma_f32_16x16x32_bf16 v[48:51], v[44:47], v[200:203], 0
    v_mfma_f32_16x16x32_bf16 v[64:67], v[44:47], v[204:207], 0
    s_nop 4
    v_rcp_f32 v227, v80
    s_nop 4
    v_rcp_f32 v231, v96
    s_nop 4
    v_rcp_f32 v219, v48
    s_nop 4
    v_rcp_f32 v223, v64
    v_mul_f32 v88, v88, v227
    v_mul_f32 v104, v104, v231
    v_mul_f32 v56, v56, v219
    v_mul_f32 v72, v72, v223
    v_mul_f32 v89, v89, v227
    v_mul_f32 v105, v105, v231
    v_mul_f32 v57, v57, v219
    v_mul_f32 v73, v73, v223
    v_mul_f32 v90, v90, v227
    v_mul_f32 v106, v106, v231
    v_mul_f32 v58, v58, v219
    v_mul_f32 v74, v74, v223
    v_mul_f32 v91, v91, v227
    v_mul_f32 v107, v107, v231
    v_mul_f32 v59, v59, v219
    v_mul_f32 v75, v75, v223
    v_cvt_pk_bf16_f32 v192, v88, v89
    v_cvt_pk_bf16_f32 v194, v104, v105
    v_cvt_pk_bf16_f32 v188, v56, v57
    v_cvt_pk_bf16_f32 v190, v72, v73
    v_cvt_pk_bf16_f32 v193, v90, v91
    v_cvt_pk_bf16_f32 v195, v106, v107
    v_cvt_pk_bf16_f32 v189, v58, v59
    v_cvt_pk_bf16_f32 v191, v74, v75
    s_movk_i32 s57, 20480
    buffer_store_dwordx4 v[188:191], v29, s[48:51], 0 offen sc1
    buffer_store_dwordx4 v[192:195], v29, s[48:51], s57 offen sc1
    v_cndmask_b32_e64 v76, v76, v60, s[76:77]
    v_cndmask_b32_e64 v108, v108, v92, s[76:77]
    v_cndmask_b32_e64 v77, v77, v61, s[76:77]
    v_cndmask_b32_e64 v109, v109, v93, s[76:77]
    v_cndmask_b32_e64 v78, v78, v62, s[76:77]
    v_cndmask_b32_e64 v110, v110, v94, s[76:77]
    v_cndmask_b32_e64 v79, v79, v63, s[76:77]
    v_cndmask_b32_e64 v111, v111, v95, s[76:77]
    v_cndmask_b32_e64 v223, v223, v219, s[76:77]
    v_cndmask_b32_e64 v231, v231, v227, s[76:77]
    v_mul_f32 v76, v76, v223
    v_mul_f32 v108, v108, v231
    v_mul_f32 v77, v77, v223
    v_mul_f32 v109, v109, v231
    v_mul_f32 v78, v78, v223
    v_mul_f32 v110, v110, v231
    v_mul_f32 v79, v79, v223
    v_mul_f32 v111, v111, v231
    v_cvt_pk_bf16_f32 v196, v76, v77
    v_cvt_pk_bf16_f32 v198, v108, v109
    v_cvt_pk_bf16_f32 v197, v78, v79
    v_cvt_pk_bf16_f32 v199, v110, v111
    s_mov_b32 exec_hi, 0
    buffer_store_dwordx2 v[196:197], v30, s[48:51], 0 offen sc1
    buffer_store_dwordx2 v[198:199], v30, s[48:51], s57 offen sc1
    s_mov_b32 exec_hi, -1
    s_mul_i32 s81, s4, 640
    s_add_u32 s81, s81, 32768
    s_lshl_b32 s75, s5, 2
    s_waitcnt vmcnt(0)
    v_readfirstlane_b32 s6, v247
    s_barrier
    s_cmp_lg_u32 s3, 0
    s_cbranch_scc1 L_nosig_11
    s_cmp_lg_u32 s6, 0
    s_cbranch_scc1 L_tagok_12
    v_mov_b32 v249, 0
    s_mov_b32 s7, 0
L_tagpoll_13:
    buffer_load_dword v248, v249, s[8:11], 0 offen sc1
    s_waitcnt vmcnt(0)
    v_readfirstlane_b32 s6, v248
    s_nop 1
    s_cmp_lg_u32 s6, 0
    s_cbranch_scc1 L_tagok_12
    s_sleep 16
    s_add_u32 s7, s7, 1
    s_cmp_lt_u32 s7, 262144
    s_cbranch_scc1 L_tagpoll_13
L_tagok_12:
    v_mov_b32 v248, s6
    v_lshlrev_b32 v249, 6, v0
    v_add_u32 v249, s75, v249
    s_mov_b64 exec, 0x3ff
    buffer_store_dword v248, v249, s[12:15], s81 offen sc1
    s_mov_b64 exec, -1
L_nosig_11:
    s_cmp_ge_u32 s99, 20
    s_cbranch_scc1 L_fin_6
    s_sub_u32 s62, s2, 160
    s_and_b32 s62, s62, 7
    s_mov_b32 s61, s99
    s_mul_i32 s57, s61, 52
    s_lshr_b32 s57, s57, 8
    s_mul_i32 s58, s57, 5
    s_sub_u32 s58, s61, s58
    s_mov_b32 s80, s58
    s_lshr_b32 s4, s62, 1
    s_lshl_b32 s4, s4, 2
    s_add_u32 s4, s4, s57
    s_and_b32 s67, s62, 1
    s_mul_i32 s67, s67, 5
    s_add_u32 s67, s67, s58
L_worker_4:
    s_setprio 0
    s_mov_b32 s44, s20
    s_mov_b32 s45, s21
    s_mov_b32 s46, 0xc8000
    s_mov_b32 s47, 0x20000
    v_lshrrev_b32 v2, 3, v0
    v_and_b32 v3, 7, v0
    v_bfe_u32 v4, v0, 4, 2
    v_lshlrev_b32 v4, 1, v4
    v_sub_u32 v3, v3, v4
    v_and_b32 v3, 7, v3
    s_lshl_b32 s66, s67, 7
    v_lshl_add_u32 v3, v3, 4, s66
    v_mul_u32_u24 v1, 1280, v2
    v_add_u32 v1, v1, v3
    s_lshr_b32 s66, s3, 1
    s_mul_i32 s66, s66, 20
    s_and_b32 s63, s3, 1
    s_lshl_b32 s64, s63, 3
    s_add_u32 s64, s64, s66
    s_mul_i32 s64, s64, 1280
    s_add_u32 s65, s66, 16
    s_mul_i32 s65, s65, 1280
    v_lshrrev_b32 v4, 2, v2
    s_lshl_b32 s63, s63, 1
    v_add_u32 v4, s63, v4
    v_lshlrev_b32 v4, 2, v4
    v_and_b32 v2, 3, v2
    s_mov_b32 s66, 0x9431
    v_mov_b32 v5, s66
    v_lshrrev_b32 v5, v4, v5
    v_and_b32 v5, 15, v5
    v_mul_u32_u24 v5, 40, v5
    v_add_u32 v5, v5, v2
    v_mul_u32_u24 v6, 1280, v5
    v_add_u32 v6, v6, v3
    s_mov_b32 s66, 0xe6cb
    v_mov_b32 v5, s66
    v_lshrrev_b32 v5, v4, v5
    v_and_b32 v5, 15, v5
    v_mul_u32_u24 v5, 40, v5
    v_add_u32 v5, v5, v2
    v_mul_u32_u24 v7, 1280, v5
    v_add_u32 v7, v7, v3
    s_mov_b32 s66, 0x7520
    v_mov_b32 v5, s66
    v_lshrrev_b32 v5, v4, v5
    v_and_b32 v5, 15, v5
    v_mul_u32_u24 v5, 40, v5
    v_add_u32 v5, v5, v2
    v_mul_u32_u24 v8, 1280, v5
    v_add_u32 v8, v8, v3
    s_mov_b32 s66, 0xfda8
    v_mov_b32 v5, s66
    v_lshrrev_b32 v5, v4, v5
    v_and_b32 v5, 15, v5
    v_mul_u32_u24 v5, 40, v5
    v_add_u32 v5, v5, v2
    v_mul_u32_u24 v9, 1280, v5
    v_add_u32 v9, v9, v3
    s_lshl_b32 s63, s3, 10
    s_add_u32 m0, s63, 0
    s_add_u32 s66, s64, 51200
    buffer_load_dwordx4 v1, s[44:47], s66 offen lds
    s_add_u32 m0, s63, 4096
    s_add_u32 s66, s64, 153600
    buffer_load_dwordx4 v1, s[44:47], s66 offen lds
    s_add_u32 m0, s63, 8192
    s_add_u32 s66, s64, 204800
    buffer_load_dwordx4 v1, s[44:47], s66 offen lds
    s_add_u32 m0, s63, 12288
    s_add_u32 s66, s64, 460800
    buffer_load_dwordx4 v1, s[44:47], s66 offen lds
    s_add_u32 m0, s63, 16384
    s_add_u32 s66, s64, 563200
    buffer_load_dwordx4 v1, s[44:47], s66 offen lds
    s_add_u32 m0, s63, 20480
    s_add_u32 s66, s64, 614400
    buffer_load_dwordx4 v1, s[44:47], s66 offen lds
    s_add_u32 m0, s63, 24576
    s_nop 0
    buffer_load_dwordx4 v6, s[44:47], s65 offen lds
    s_add_u32 m0, s63, 28672
    s_add_u32 s66, s64, 0
    buffer_load_dwordx4 v1, s[44:47], s66 offen lds
    s_add_u32 m0, s63, 32768
    s_add_u32 s66, s64, 102400
    buffer_load_dwordx4 v1, s[44:47], s66 offen lds
    s_add_u32 m0, s63, 36864
    s_add_u32 s66, s64, 256000
    buffer_load_dwordx4 v1, s[44:47], s66 offen lds
    s_add_u32 m0, s63, 40960
    s_add_u32 s66, s64, 307200
    buffer_load_dwordx4 v1, s[44:47], s66 offen lds
    s_add_u32 m0, s63, 45056
    s_add_u32 s66, s64, 358400
    buffer_load_dwordx4 v1, s[44:47], s66 offen lds
    s_add_u32 m0, s63, 49152
    s_add_u32 s66, s64, 409600
    buffer_load_dwordx4 v1, s[44:47], s66 offen lds
    s_add_u32 m0, s63, 53248
    s_add_u32 s66, s64, 512000
    buffer_load_dwordx4 v1, s[44:47], s66 offen lds
    s_add_u32 m0, s63, 57344
    s_add_u32 s66, s64, 665600
    buffer_load_dwordx4 v1, s[44:47], s66 offen lds
    s_add_u32 m0, s63, 61440
    s_add_u32 s66, s64, 716800
    buffer_load_dwordx4 v1, s[44:47], s66 offen lds
    s_add_u32 m0, s63, 65536
    s_add_u32 s66, s64, 768000
    buffer_load_dwordx4 v1, s[44:47], s66 offen lds
    s_add_u32 m0, s63, 69632
    s_nop 0
    buffer_load_dwordx4 v7, s[44:47], s65 offen lds
    s_add_u32 m0, s63, 73728
    s_nop 0
    buffer_load_dwordx4 v8, s[44:47], s65 offen lds
    s_add_u32 m0, s63, 77824
    s_nop 0
    buffer_load_dwordx4 v9, s[44:47], s65 offen lds
    s_mov_b32 s52, s34
    s_mov_b32 s53, s35
    s_mov_b32 s54, 0x500000
    s_mov_b32 s55, 0x20000
    s_lshl_b32 s57, s4, 3
    s_lshl_b32 s59, s3, 1
    s_add_u32 s57, s57, s59
    s_mov_b32 s78, s57
    s_mul_i32 s57, s57, 20480
    s_mov_b32 s81, s57
    v_lshl_add_u32 v10, v0, 4, s57
    v_add_u32 v11, 20480, v10
    v_lshrrev_b32 v2, 4, v0
    v_bfe_u32 v3, v0, 2, 2
    v_and_b32 v4, 3, v0
    v_lshl_add_u32 v5, v2, 2, v3
    v_lshlrev_b32 v5, 7, v5
    v_and_b32 v2, 1, v2
    v_lshlrev_b32 v2, 1, v2
    v_lshrrev_b32 v3, 1, v3
    v_add_u32 v2, v2, v3
    v_lshlrev_b32 v2, 5, v2
    v_lshl_add_u32 v2, v4, 3, v2
    v_add_u32 v3, 0, v2
    v_and_b32 v3, 127, v3
    v_add_u32 v12, v5, v3
    v_add_u32 v3, 32, v2
    v_and_b32 v3, 127, v3
    v_add_u32 v13, v5, v3
    v_add_u32 v3, 64, v2
    v_and_b32 v3, 127, v3
    v_add_u32 v14, v5, v3
    v_add_u32 v3, 96, v2
    v_and_b32 v3, 127, v3
    v_add_u32 v15, v5, v3
    v_mov_b64 v[176:177], 0
    v_mov_b64 v[178:179], 0
    v_mov_b64 v[180:181], 0
    v_mov_b64 v[182:183], 0
    v_mov_b64 v[184:185], 0
    v_mov_b64 v[186:187], 0
    v_mov_b64 v[188:189], 0
    v_mov_b64 v[190:191], 0
    v_mov_b64 v[192:193], 0
    v_mov_b64 v[194:195], 0
    v_mov_b64 v[196:197], 0
    v_mov_b64 v[198:199], 0
    v_mov_b64 v[200:201], 0
    v_mov_b64 v[202:203], 0
    v_mov_b64 v[204:205], 0
    v_mov_b64 v[206:207], 0
    s_mul_i32 s75, s4, 640
    s_lshl_b32 s57, s67, 6
    s_add_u32 s75, s75, s57
    s_add_u32 s75, s75, 32768
    s_waitcnt vmcnt(0)
    s_mov_b32 s70, 0
    s_mov_b32 s71, 4096
    s_mov_b32 s72, 8192
    s_mov_b32 s73, 12288
    s_mov_b32 s74, 16384
    s_cmp_lg_u32 s3, 0
    s_cbranch_scc1 L_nowait_14
    s_cmp_lg_u32 s6, 0
    s_cbranch_scc1 L_tagok_17
    v_mov_b32 v249, 0
    s_mov_b32 s7, 0
L_tagpoll_18:
    buffer_load_dword v248, v249, s[8:11], 0 offen sc1
    s_waitcnt vmcnt(0)
    v_readfirstlane_b32 s6, v248
    s_nop 1
    s_cmp_lg_u32 s6, 0
    s_cbranch_scc1 L_tagok_17
    s_sleep 16
    s_add_u32 s7, s7, 1
    s_cmp_lt_u32 s7, 262144
    s_cbranch_scc1 L_tagpoll_18
L_tagok_17:
    s_mov_b32 s7, 0
    v_and_b32 v249, 15, v0
    v_lshlrev_b32 v249, 2, v249
L_poll_15:
    buffer_load_dword v248, v249, s[12:15], s75 offen sc1
    s_waitcnt vmcnt(0)
    v_cmp_ne_u32 vcc, s6, v248
    s_nop 1
    s_cmp_eq_u64 vcc, 0
    s_cbranch_scc1 L_polled_16
    s_sleep 12
    s_add_u32 s7, s7, 1
    s_cmp_lt_u32 s7, 262144
    s_cbranch_scc1 L_poll_15
L_polled_16:
L_nowait_14:
    s_barrier
    buffer_load_dwordx4 v[16:19], v10, s[48:51], s70 offen offset:1024
    buffer_load_dwordx4 v[96:99], v11, s[48:51], s70 offen offset:1024
    buffer_load_dwordx4 v[20:23], v10, s[48:51], s70 offen offset:3072
    buffer_load_dwordx4 v[100:103], v11, s[48:51], s70 offen offset:3072
    buffer_load_dwordx4 v[24:27], v10, s[48:51], s71 offen offset:0
    buffer_load_dwordx4 v[104:107], v11, s[48:51], s71 offen offset:0
    buffer_load_dwordx4 v[28:31], v10, s[48:51], s72 offen offset:1024
    buffer_load_dwordx4 v[108:111], v11, s[48:51], s72 offen offset:1024
    buffer_load_dwordx4 v[32:35], v10, s[48:51], s72 offen offset:3072
    buffer_load_dwordx4 v[112:115], v11, s[48:51], s72 offen offset:3072
    buffer_load_dwordx4 v[36:39], v10, s[48:51], s73 offen offset:0
    buffer_load_dwordx4 v[116:119], v11, s[48:51], s73 offen offset:0
    ds_read_b64_tr_b16 v[208:209], v12 offset:0
    ds_read_b64_tr_b16 v[210:211], v12 offset:2048
    ds_read_b64_tr_b16 v[212:213], v13 offset:0
    ds_read_b64_tr_b16 v[214:215], v13 offset:2048
    ds_read_b64_tr_b16 v[216:217], v14 offset:0
    ds_read_b64_tr_b16 v[218:219], v14 offset:2048
    ds_read_b64_tr_b16 v[220:221], v15 offset:0
    ds_read_b64_tr_b16 v[222:223], v15 offset:2048
    s_waitcnt vmcnt(10) lgkmcnt(0)
    v_mfma_f32_16x16x32_bf16 v[176:179], v[208:211], v[16:19], v[176:179]
    ds_read_b64_tr_b16 v[224:225], v12 offset:4096
    ds_read_b64_tr_b16 v[226:227], v12 offset:6144
    v_mfma_f32_16x16x32_bf16 v[192:195], v[208:211], v[96:99], v[192:195]
    ds_read_b64_tr_b16 v[228:229], v13 offset:4096
    ds_read_b64_tr_b16 v[230:231], v13 offset:6144
    v_mfma_f32_16x16x32_bf16 v[180:183], v[212:215], v[16:19], v[180:183]
    ds_read_b64_tr_b16 v[232:233], v14 offset:4096
    ds_read_b64_tr_b16 v[234:235], v14 offset:6144
    v_mfma_f32_16x16x32_bf16 v[196:199], v[212:215], v[96:99], v[196:199]
    ds_read_b64_tr_b16 v[236:237], v15 offset:4096
    ds_read_b64_tr_b16 v[238:239], v15 offset:6144
    v_mfma_f32_16x16x32_bf16 v[184:187], v[216:219], v[16:19], v[184:187]
    v_mfma_f32_16x16x32_bf16 v[200:203], v[216:219], v[96:99], v[200:203]
    buffer_load_dwordx4 v[40:43], v10, s[48:51], s74 offen offset:0
    buffer_load_dwordx4 v[120:123], v11, s[48:51], s74 offen offset:0
    v_mfma_f32_16x16x32_bf16 v[188:191], v[220:223], v[16:19], v[188:191]
    v_mfma_f32_16x16x32_bf16 v[204:207], v[220:223], v[96:99], v[204:207]
    s_waitcnt vmcnt(10) lgkmcnt(0)
    v_mfma_f32_16x16x32_bf16 v[176:179], v[224:227], v[20:23], v[176:179]
    ds_read_b64_tr_b16 v[208:209], v12 offset:8192
    ds_read_b64_tr_b16 v[210:211], v12 offset:10240
    v_mfma_f32_16x16x32_bf16 v[192:195], v[224:227], v[100:103], v[192:195]
    ds_read_b64_tr_b16 v[212:213], v13 offset:8192
    ds_read_b64_tr_b16 v[214:215], v13 offset:10240
    v_mfma_f32_16x16x32_bf16 v[180:183], v[228:231], v[20:23], v[180:183]
    ds_read_b64_tr_b16 v[216:217], v14 offset:8192
    ds_read_b64_tr_b16 v[218:219], v14 offset:10240
    v_mfma_f32_16x16x32_bf16 v[196:199], v[228:231], v[100:103], v[196:199]
    ds_read_b64_tr_b16 v[220:221], v15 offset:8192
    ds_read_b64_tr_b16 v[222:223], v15 offset:10240
    v_mfma_f32_16x16x32_bf16 v[184:187], v[232:235], v[20:23], v[184:187]
    v_mfma_f32_16x16x32_bf16 v[200:203], v[232:235], v[100:103], v[200:203]
    buffer_load_dwordx4 v[44:47], v10, s[48:51], s70 offen offset:0
    buffer_load_dwordx4 v[124:127], v11, s[48:51], s70 offen offset:0
    v_mfma_f32_16x16x32_bf16 v[188:191], v[236:239], v[20:23], v[188:191]
    v_mfma_f32_16x16x32_bf16 v[204:207], v[236:239], v[100:103], v[204:207]
    s_waitcnt vmcnt(10) lgkmcnt(0)
    v_mfma_f32_16x16x32_bf16 v[176:179], v[208:211], v[24:27], v[176:179]
    ds_read_b64_tr_b16 v[224:225], v12 offset:12288
    ds_read_b64_tr_b16 v[226:227], v12 offset:14336
    v_mfma_f32_16x16x32_bf16 v[192:195], v[208:211], v[104:107], v[192:195]
    ds_read_b64_tr_b16 v[228:229], v13 offset:12288
    ds_read_b64_tr_b16 v[230:231], v13 offset:14336
    v_mfma_f32_16x16x32_bf16 v[180:183], v[212:215], v[24:27], v[180:183]
    ds_read_b64_tr_b16 v[232:233], v14 offset:12288
    ds_read_b64_tr_b16 v[234:235], v14 offset:14336
    v_mfma_f32_16x16x32_bf16 v[196:199], v[212:215], v[104:107], v[196:199]
    ds_read_b64_tr_b16 v[236:237], v15 offset:12288
    ds_read_b64_tr_b16 v[238:239], v15 offset:14336
    v_mfma_f32_16x16x32_bf16 v[184:187], v[216:219], v[24:27], v[184:187]
    v_mfma_f32_16x16x32_bf16 v[200:203], v[216:219], v[104:107], v[200:203]
    buffer_load_dwordx4 v[48:51], v10, s[48:51], s70 offen offset:2048
    buffer_load_dwordx4 v[128:131], v11, s[48:51], s70 offen offset:2048
    v_mfma_f32_16x16x32_bf16 v[188:191], v[220:223], v[24:27], v[188:191]
    v_mfma_f32_16x16x32_bf16 v[204:207], v[220:223], v[104:107], v[204:207]
    s_waitcnt vmcnt(10) lgkmcnt(0)
    v_mfma_f32_16x16x32_bf16 v[176:179], v[224:227], v[28:31], v[176:179]
    ds_read_b64_tr_b16 v[208:209], v12 offset:16384
    ds_read_b64_tr_b16 v[210:211], v12 offset:18432
    v_mfma_f32_16x16x32_bf16 v[192:195], v[224:227], v[108:111], v[192:195]
    ds_read_b64_tr_b16 v[212:213], v13 offset:16384
    ds_read_b64_tr_b16 v[214:215], v13 offset:18432
    v_mfma_f32_16x16x32_bf16 v[180:183], v[228:231], v[28:31], v[180:183]
    ds_read_b64_tr_b16 v[216:217], v14 offset:16384
    ds_read_b64_tr_b16 v[218:219], v14 offset:18432
    v_mfma_f32_16x16x32_bf16 v[196:199], v[228:231], v[108:111], v[196:199]
    ds_read_b64_tr_b16 v[220:221], v15 offset:16384
    ds_read_b64_tr_b16 v[222:223], v15 offset:18432
    v_mfma_f32_16x16x32_bf16 v[184:187], v[232:235], v[28:31], v[184:187]
    v_mfma_f32_16x16x32_bf16 v[200:203], v[232:235], v[108:111], v[200:203]
    buffer_load_dwordx4 v[52:55], v10, s[48:51], s71 offen offset:1024
    buffer_load_dwordx4 v[132:135], v11, s[48:51], s71 offen offset:1024
    v_mfma_f32_16x16x32_bf16 v[188:191], v[236:239], v[28:31], v[188:191]
    v_mfma_f32_16x16x32_bf16 v[204:207], v[236:239], v[108:111], v[204:207]
    s_waitcnt vmcnt(10) lgkmcnt(0)
    v_mfma_f32_16x16x32_bf16 v[176:179], v[208:211], v[32:35], v[176:179]
    ds_read_b64_tr_b16 v[224:225], v12 offset:20480
    ds_read_b64_tr_b16 v[226:227], v12 offset:22528
    v_mfma_f32_16x16x32_bf16 v[192:195], v[208:211], v[112:115], v[192:195]
    ds_read_b64_tr_b16 v[228:229], v13 offset:20480
    ds_read_b64_tr_b16 v[230:231], v13 offset:22528
    v_mfma_f32_16x16x32_bf16 v[180:183], v[212:215], v[32:35], v[180:183]
    ds_read_b64_tr_b16 v[232:233], v14 offset:20480
    ds_read_b64_tr_b16 v[234:235], v14 offset:22528
    v_mfma_f32_16x16x32_bf16 v[196:199], v[212:215], v[112:115], v[196:199]
    ds_read_b64_tr_b16 v[236:237], v15 offset:20480
    ds_read_b64_tr_b16 v[238:239], v15 offset:22528
    v_mfma_f32_16x16x32_bf16 v[184:187], v[216:219], v[32:35], v[184:187]
    v_mfma_f32_16x16x32_bf16 v[200:203], v[216:219], v[112:115], v[200:203]
    buffer_load_dwordx4 v[56:59], v10, s[48:51], s71 offen offset:2048
    buffer_load_dwordx4 v[136:139], v11, s[48:51], s71 offen offset:2048
    v_mfma_f32_16x16x32_bf16 v[188:191], v[220:223], v[32:35], v[188:191]
    v_mfma_f32_16x16x32_bf16 v[204:207], v[220:223], v[112:115], v[204:207]
    s_waitcnt vmcnt(10) lgkmcnt(0)
    v_mfma_f32_16x16x32_bf16 v[176:179], v[224:227], v[36:39], v[176:179]
    ds_read_b64_tr_b16 v[208:209], v12 offset:24576
    ds_read_b64_tr_b16 v[210:211], v12 offset:26624
    v_mfma_f32_16x16x32_bf16 v[192:195], v[224:227], v[116:119], v[192:195]
    ds_read_b64_tr_b16 v[212:213], v13 offset:24576
    ds_read_b64_tr_b16 v[214:215], v13 offset:26624
    v_mfma_f32_16x16x32_bf16 v[180:183], v[228:231], v[36:39], v[180:183]
    ds_read_b64_tr_b16 v[216:217], v14 offset:24576
    ds_read_b64_tr_b16 v[218:219], v14 offset:26624
    v_mfma_f32_16x16x32_bf16 v[196:199], v[228:231], v[116:119], v[196:199]
    ds_read_b64_tr_b16 v[220:221], v15 offset:24576
    ds_read_b64_tr_b16 v[222:223], v15 offset:26624
    v_mfma_f32_16x16x32_bf16 v[184:187], v[232:235], v[36:39], v[184:187]
    v_mfma_f32_16x16x32_bf16 v[200:203], v[232:235], v[116:119], v[200:203]
    buffer_load_dwordx4 v[60:63], v10, s[48:51], s71 offen offset:3072
    buffer_load_dwordx4 v[140:143], v11, s[48:51], s71 offen offset:3072
    v_mfma_f32_16x16x32_bf16 v[188:191], v[236:239], v[36:39], v[188:191]
    v_mfma_f32_16x16x32_bf16 v[204:207], v[236:239], v[116:119], v[204:207]
    s_waitcnt vmcnt(10) lgkmcnt(0)
    v_mfma_f32_16x16x32_bf16 v[176:179], v[208:211], v[40:43], v[176:179]
    ds_read_b64_tr_b16 v[224:225], v12 offset:28672
    ds_read_b64_tr_b16 v[226:227], v12 offset:30720
    v_mfma_f32_16x16x32_bf16 v[192:195], v[208:211], v[120:123], v[192:195]
    ds_read_b64_tr_b16 v[228:229], v13 offset:28672
    ds_read_b64_tr_b16 v[230:231], v13 offset:30720
    v_mfma_f32_16x16x32_bf16 v[180:183], v[212:215], v[40:43], v[180:183]
    ds_read_b64_tr_b16 v[232:233], v14 offset:28672
    ds_read_b64_tr_b16 v[234:235], v14 offset:30720
    v_mfma_f32_16x16x32_bf16 v[196:199], v[212:215], v[120:123], v[196:199]
    ds_read_b64_tr_b16 v[236:237], v15 offset:28672
    ds_read_b64_tr_b16 v[238:239], v15 offset:30720
    v_mfma_f32_16x16x32_bf16 v[184:187], v[216:219], v[40:43], v[184:187]
    v_mfma_f32_16x16x32_bf16 v[200:203], v[216:219], v[120:123], v[200:203]
    buffer_load_dwordx4 v[64:67], v10, s[48:51], s72 offen offset:0
    buffer_load_dwordx4 v[144:147], v11, s[48:51], s72 offen offset:0
    v_mfma_f32_16x16x32_bf16 v[188:191], v[220:223], v[40:43], v[188:191]
    v_mfma_f32_16x16x32_bf16 v[204:207], v[220:223], v[120:123], v[204:207]
    s_waitcnt vmcnt(10) lgkmcnt(0)
    v_mfma_f32_16x16x32_bf16 v[176:179], v[224:227], v[44:47], v[176:179]
    ds_read_b64_tr_b16 v[208:209], v12 offset:32768
    ds_read_b64_tr_b16 v[210:211], v12 offset:34816
    v_mfma_f32_16x16x32_bf16 v[192:195], v[224:227], v[124:127], v[192:195]
    ds_read_b64_tr_b16 v[212:213], v13 offset:32768
    ds_read_b64_tr_b16 v[214:215], v13 offset:34816
    v_mfma_f32_16x16x32_bf16 v[180:183], v[228:231], v[44:47], v[180:183]
    ds_read_b64_tr_b16 v[216:217], v14 offset:32768
    ds_read_b64_tr_b16 v[218:219], v14 offset:34816
    v_mfma_f32_16x16x32_bf16 v[196:199], v[228:231], v[124:127], v[196:199]
    ds_read_b64_tr_b16 v[220:221], v15 offset:32768
    ds_read_b64_tr_b16 v[222:223], v15 offset:34816
    v_mfma_f32_16x16x32_bf16 v[184:187], v[232:235], v[44:47], v[184:187]
    v_mfma_f32_16x16x32_bf16 v[200:203], v[232:235], v[124:127], v[200:203]
    buffer_load_dwordx4 v[68:71], v10, s[48:51], s72 offen offset:2048
    buffer_load_dwordx4 v[148:151], v11, s[48:51], s72 offen offset:2048
    v_mfma_f32_16x16x32_bf16 v[188:191], v[236:239], v[44:47], v[188:191]
    v_mfma_f32_16x16x32_bf16 v[204:207], v[236:239], v[124:127], v[204:207]
    s_waitcnt vmcnt(10) lgkmcnt(0)
    v_mfma_f32_16x16x32_bf16 v[176:179], v[208:211], v[48:51], v[176:179]
    ds_read_b64_tr_b16 v[224:225], v12 offset:36864
    ds_read_b64_tr_b16 v[226:227], v12 offset:38912
    v_mfma_f32_16x16x32_bf16 v[192:195], v[208:211], v[128:131], v[192:195]
    ds_read_b64_tr_b16 v[228:229], v13 offset:36864
    ds_read_b64_tr_b16 v[230:231], v13 offset:38912
    v_mfma_f32_16x16x32_bf16 v[180:183], v[212:215], v[48:51], v[180:183]
    ds_read_b64_tr_b16 v[232:233], v14 offset:36864
    ds_read_b64_tr_b16 v[234:235], v14 offset:38912
    v_mfma_f32_16x16x32_bf16 v[196:199], v[212:215], v[128:131], v[196:199]
    ds_read_b64_tr_b16 v[236:237], v15 offset:36864
    ds_read_b64_tr_b16 v[238:239], v15 offset:38912
    v_mfma_f32_16x16x32_bf16 v[184:187], v[216:219], v[48:51], v[184:187]
    v_mfma_f32_16x16x32_bf16 v[200:203], v[216:219], v[128:131], v[200:203]
    buffer_load_dwordx4 v[72:75], v10, s[48:51], s73 offen offset:1024
    buffer_load_dwordx4 v[152:155], v11, s[48:51], s73 offen offset:1024
    v_mfma_f32_16x16x32_bf16 v[188:191], v[220:223], v[48:51], v[188:191]
    v_mfma_f32_16x16x32_bf16 v[204:207], v[220:223], v[128:131], v[204:207]
    s_waitcnt vmcnt(10) lgkmcnt(0)
    v_mfma_f32_16x16x32_bf16 v[176:179], v[224:227], v[52:55], v[176:179]
    ds_read_b64_tr_b16 v[208:209], v12 offset:40960
    ds_read_b64_tr_b16 v[210:211], v12 offset:43008
    v_mfma_f32_16x16x32_bf16 v[192:195], v[224:227], v[132:135], v[192:195]
    ds_read_b64_tr_b16 v[212:213], v13 offset:40960
    ds_read_b64_tr_b16 v[214:215], v13 offset:43008
    v_mfma_f32_16x16x32_bf16 v[180:183], v[228:231], v[52:55], v[180:183]
    ds_read_b64_tr_b16 v[216:217], v14 offset:40960
    ds_read_b64_tr_b16 v[218:219], v14 offset:43008
    v_mfma_f32_16x16x32_bf16 v[196:199], v[228:231], v[132:135], v[196:199]
    ds_read_b64_tr_b16 v[220:221], v15 offset:40960
    ds_read_b64_tr_b16 v[222:223], v15 offset:43008
    v_mfma_f32_16x16x32_bf16 v[184:187], v[232:235], v[52:55], v[184:187]
    v_mfma_f32_16x16x32_bf16 v[200:203], v[232:235], v[132:135], v[200:203]
    buffer_load_dwordx4 v[76:79], v10, s[48:51], s73 offen offset:2048
    buffer_load_dwordx4 v[156:159], v11, s[48:51], s73 offen offset:2048
    v_mfma_f32_16x16x32_bf16 v[188:191], v[236:239], v[52:55], v[188:191]
    v_mfma_f32_16x16x32_bf16 v[204:207], v[236:239], v[132:135], v[204:207]
    s_waitcnt vmcnt(10) lgkmcnt(0)
    v_mfma_f32_16x16x32_bf16 v[176:179], v[208:211], v[56:59], v[176:179]
    ds_read_b64_tr_b16 v[224:225], v12 offset:45056
    ds_read_b64_tr_b16 v[226:227], v12 offset:47104
    v_mfma_f32_16x16x32_bf16 v[192:195], v[208:211], v[136:139], v[192:195]
    ds_read_b64_tr_b16 v[228:229], v13 offset:45056
    ds_read_b64_tr_b16 v[230:231], v13 offset:47104
    v_mfma_f32_16x16x32_bf16 v[180:183], v[212:215], v[56:59], v[180:183]
    ds_read_b64_tr_b16 v[232:233], v14 offset:45056
    ds_read_b64_tr_b16 v[234:235], v14 offset:47104
    v_mfma_f32_16x16x32_bf16 v[196:199], v[212:215], v[136:139], v[196:199]
    ds_read_b64_tr_b16 v[236:237], v15 offset:45056
    ds_read_b64_tr_b16 v[238:239], v15 offset:47104
    v_mfma_f32_16x16x32_bf16 v[184:187], v[216:219], v[56:59], v[184:187]
    v_mfma_f32_16x16x32_bf16 v[200:203], v[216:219], v[136:139], v[200:203]
    buffer_load_dwordx4 v[80:83], v10, s[48:51], s73 offen offset:3072
    buffer_load_dwordx4 v[160:163], v11, s[48:51], s73 offen offset:3072
    v_mfma_f32_16x16x32_bf16 v[188:191], v[220:223], v[56:59], v[188:191]
    v_mfma_f32_16x16x32_bf16 v[204:207], v[220:223], v[136:139], v[204:207]
    s_waitcnt vmcnt(10) lgkmcnt(0)
    v_mfma_f32_16x16x32_bf16 v[176:179], v[224:227], v[60:63], v[176:179]
    ds_read_b64_tr_b16 v[208:209], v12 offset:49152
    ds_read_b64_tr_b16 v[210:211], v12 offset:51200
    v_mfma_f32_16x16x32_bf16 v[192:195], v[224:227], v[140:143], v[192:195]
    ds_read_b64_tr_b16 v[212:213], v13 offset:49152
    ds_read_b64_tr_b16 v[214:215], v13 offset:51200
    v_mfma_f32_16x16x32_bf16 v[180:183], v[228:231], v[60:63], v[180:183]
    ds_read_b64_tr_b16 v[216:217], v14 offset:49152
    ds_read_b64_tr_b16 v[218:219], v14 offset:51200
    v_mfma_f32_16x16x32_bf16 v[196:199], v[228:231], v[140:143], v[196:199]
    ds_read_b64_tr_b16 v[220:221], v15 offset:49152
    ds_read_b64_tr_b16 v[222:223], v15 offset:51200
    v_mfma_f32_16x16x32_bf16 v[184:187], v[232:235], v[60:63], v[184:187]
    v_mfma_f32_16x16x32_bf16 v[200:203], v[232:235], v[140:143], v[200:203]
    buffer_load_dwordx4 v[84:87], v10, s[48:51], s74 offen offset:1024
    buffer_load_dwordx4 v[164:167], v11, s[48:51], s74 offen offset:1024
    v_mfma_f32_16x16x32_bf16 v[188:191], v[236:239], v[60:63], v[188:191]
    v_mfma_f32_16x16x32_bf16 v[204:207], v[236:239], v[140:143], v[204:207]
    s_waitcnt vmcnt(10) lgkmcnt(0)
    v_mfma_f32_16x16x32_bf16 v[176:179], v[208:211], v[64:67], v[176:179]
    ds_read_b64_tr_b16 v[224:225], v12 offset:53248
    ds_read_b64_tr_b16 v[226:227], v12 offset:55296
    v_mfma_f32_16x16x32_bf16 v[192:195], v[208:211], v[144:147], v[192:195]
    ds_read_b64_tr_b16 v[228:229], v13 offset:53248
    ds_read_b64_tr_b16 v[230:231], v13 offset:55296
    v_mfma_f32_16x16x32_bf16 v[180:183], v[212:215], v[64:67], v[180:183]
    ds_read_b64_tr_b16 v[232:233], v14 offset:53248
    ds_read_b64_tr_b16 v[234:235], v14 offset:55296
    v_mfma_f32_16x16x32_bf16 v[196:199], v[212:215], v[144:147], v[196:199]
    ds_read_b64_tr_b16 v[236:237], v15 offset:53248
    ds_read_b64_tr_b16 v[238:239], v15 offset:55296
    v_mfma_f32_16x16x32_bf16 v[184:187], v[216:219], v[64:67], v[184:187]
    v_mfma_f32_16x16x32_bf16 v[200:203], v[216:219], v[144:147], v[200:203]
    buffer_load_dwordx4 v[88:91], v10, s[48:51], s74 offen offset:2048
    buffer_load_dwordx4 v[168:171], v11, s[48:51], s74 offen offset:2048
    v_mfma_f32_16x16x32_bf16 v[188:191], v[220:223], v[64:67], v[188:191]
    v_mfma_f32_16x16x32_bf16 v[204:207], v[220:223], v[144:147], v[204:207]
    s_waitcnt vmcnt(10) lgkmcnt(0)
    v_mfma_f32_16x16x32_bf16 v[176:179], v[224:227], v[68:71], v[176:179]
    ds_read_b64_tr_b16 v[208:209], v12 offset:57344
    ds_read_b64_tr_b16 v[210:211], v12 offset:59392
    v_mfma_f32_16x16x32_bf16 v[192:195], v[224:227], v[148:151], v[192:195]
    ds_read_b64_tr_b16 v[212:213], v13 offset:57344
    ds_read_b64_tr_b16 v[214:215], v13 offset:59392
    v_mfma_f32_16x16x32_bf16 v[180:183], v[228:231], v[68:71], v[180:183]
    ds_read_b64_tr_b16 v[216:217], v14 offset:57344
    ds_read_b64_tr_b16 v[218:219], v14 offset:59392
    v_mfma_f32_16x16x32_bf16 v[196:199], v[228:231], v[148:151], v[196:199]
    ds_read_b64_tr_b16 v[220:221], v15 offset:57344
    ds_read_b64_tr_b16 v[222:223], v15 offset:59392
    v_mfma_f32_16x16x32_bf16 v[184:187], v[232:235], v[68:71], v[184:187]
    v_mfma_f32_16x16x32_bf16 v[200:203], v[232:235], v[148:151], v[200:203]
    buffer_load_dwordx4 v[92:95], v10, s[48:51], s74 offen offset:3072
    buffer_load_dwordx4 v[172:175], v11, s[48:51], s74 offen offset:3072
    v_mfma_f32_16x16x32_bf16 v[188:191], v[236:239], v[68:71], v[188:191]
    v_mfma_f32_16x16x32_bf16 v[204:207], v[236:239], v[148:151], v[204:207]
    s_waitcnt vmcnt(10) lgkmcnt(0)
    v_mfma_f32_16x16x32_bf16 v[176:179], v[208:211], v[72:75], v[176:179]
    ds_read_b64_tr_b16 v[224:225], v12 offset:61440
    ds_read_b64_tr_b16 v[226:227], v12 offset:63488
    v_mfma_f32_16x16x32_bf16 v[192:195], v[208:211], v[152:155], v[192:195]
    ds_read_b64_tr_b16 v[228:229], v13 offset:61440
    ds_read_b64_tr_b16 v[230:231], v13 offset:63488
    v_mfma_f32_16x16x32_bf16 v[180:183], v[212:215], v[72:75], v[180:183]
    ds_read_b64_tr_b16 v[232:233], v14 offset:61440
    ds_read_b64_tr_b16 v[234:235], v14 offset:63488
    v_mfma_f32_16x16x32_bf16 v[196:199], v[212:215], v[152:155], v[196:199]
    ds_read_b64_tr_b16 v[236:237], v15 offset:61440
    ds_read_b64_tr_b16 v[238:239], v15 offset:63488
    v_mfma_f32_16x16x32_bf16 v[184:187], v[216:219], v[72:75], v[184:187]
    v_mfma_f32_16x16x32_bf16 v[200:203], v[216:219], v[152:155], v[200:203]
    v_mfma_f32_16x16x32_bf16 v[188:191], v[220:223], v[72:75], v[188:191]
    v_mfma_f32_16x16x32_bf16 v[204:207], v[220:223], v[152:155], v[204:207]
    v_add_u32 v12, 40960, v12
    v_add_u32 v13, 40960, v13
    v_add_u32 v14, 40960, v14
    v_add_u32 v15, 40960, v15
    s_waitcnt vmcnt(8) lgkmcnt(0)
    v_mfma_f32_16x16x32_bf16 v[176:179], v[224:227], v[76:79], v[176:179]
    ds_read_b64_tr_b16 v[208:209], v12 offset:24576
    ds_read_b64_tr_b16 v[210:211], v12 offset:26624
    v_mfma_f32_16x16x32_bf16 v[192:195], v[224:227], v[156:159], v[192:195]
    ds_read_b64_tr_b16 v[212:213], v13 offset:24576
    ds_read_b64_tr_b16 v[214:215], v13 offset:26624
    v_mfma_f32_16x16x32_bf16 v[180:183], v[228:231], v[76:79], v[180:183]
    ds_read_b64_tr_b16 v[216:217], v14 offset:24576
    ds_read_b64_tr_b16 v[218:219], v14 offset:26624
    v_mfma_f32_16x16x32_bf16 v[196:199], v[228:231], v[156:159], v[196:199]
    ds_read_b64_tr_b16 v[220:221], v15 offset:24576
    ds_read_b64_tr_b16 v[222:223], v15 offset:26624
    v_mfma_f32_16x16x32_bf16 v[184:187], v[232:235], v[76:79], v[184:187]
    v_mfma_f32_16x16x32_bf16 v[200:203], v[232:235], v[156:159], v[200:203]
    v_mfma_f32_16x16x32_bf16 v[188:191], v[236:239], v[76:79], v[188:191]
    v_mfma_f32_16x16x32_bf16 v[204:207], v[236:239], v[156:159], v[204:207]
    s_waitcnt vmcnt(6) lgkmcnt(0)
    v_mfma_f32_16x16x32_bf16 v[176:179], v[208:211], v[80:83], v[176:179]
    ds_read_b64_tr_b16 v[224:225], v12 offset:28672
    ds_read_b64_tr_b16 v[226:227], v12 offset:30720
    v_mfma_f32_16x16x32_bf16 v[192:195], v[208:211], v[160:163], v[192:195]
    ds_read_b64_tr_b16 v[228:229], v13 offset:28672
    ds_read_b64_tr_b16 v[230:231], v13 offset:30720
    v_mfma_f32_16x16x32_bf16 v[180:183], v[212:215], v[80:83], v[180:183]
    ds_read_b64_tr_b16 v[232:233], v14 offset:28672
    ds_read_b64_tr_b16 v[234:235], v14 offset:30720
    v_mfma_f32_16x16x32_bf16 v[196:199], v[212:215], v[160:163], v[196:199]
    ds_read_b64_tr_b16 v[236:237], v15 offset:28672
    ds_read_b64_tr_b16 v[238:239], v15 offset:30720
    v_mfma_f32_16x16x32_bf16 v[184:187], v[216:219], v[80:83], v[184:187]
    v_mfma_f32_16x16x32_bf16 v[200:203], v[216:219], v[160:163], v[200:203]
    v_mfma_f32_16x16x32_bf16 v[188:191], v[220:223], v[80:83], v[188:191]
    v_mfma_f32_16x16x32_bf16 v[204:207], v[220:223], v[160:163], v[204:207]
    s_waitcnt vmcnt(4) lgkmcnt(0)
    v_mfma_f32_16x16x32_bf16 v[176:179], v[224:227], v[84:87], v[176:179]
    ds_read_b64_tr_b16 v[208:209], v12 offset:32768
    ds_read_b64_tr_b16 v[210:211], v12 offset:34816
    v_mfma_f32_16x16x32_bf16 v[192:195], v[224:227], v[164:167], v[192:195]
    ds_read_b64_tr_b16 v[212:213], v13 offset:32768
    ds_read_b64_tr_b16 v[214:215], v13 offset:34816
    v_mfma_f32_16x16x32_bf16 v[180:183], v[228:231], v[84:87], v[180:183]
    ds_read_b64_tr_b16 v[216:217], v14 offset:32768
    ds_read_b64_tr_b16 v[218:219], v14 offset:34816
    v_mfma_f32_16x16x32_bf16 v[196:199], v[228:231], v[164:167], v[196:199]
    ds_read_b64_tr_b16 v[220:221], v15 offset:32768
    ds_read_b64_tr_b16 v[222:223], v15 offset:34816
    v_mfma_f32_16x16x32_bf16 v[184:187], v[232:235], v[84:87], v[184:187]
    v_mfma_f32_16x16x32_bf16 v[200:203], v[232:235], v[164:167], v[200:203]
    v_mfma_f32_16x16x32_bf16 v[188:191], v[236:239], v[84:87], v[188:191]
    v_mfma_f32_16x16x32_bf16 v[204:207], v[236:239], v[164:167], v[204:207]
    s_waitcnt vmcnt(2) lgkmcnt(0)
    v_mfma_f32_16x16x32_bf16 v[176:179], v[208:211], v[88:91], v[176:179]
    ds_read_b64_tr_b16 v[224:225], v12 offset:36864
    ds_read_b64_tr_b16 v[226:227], v12 offset:38912
    v_mfma_f32_16x16x32_bf16 v[192:195], v[208:211], v[168:171], v[192:195]
    ds_read_b64_tr_b16 v[228:229], v13 offset:36864
    ds_read_b64_tr_b16 v[230:231], v13 offset:38912
    v_mfma_f32_16x16x32_bf16 v[180:183], v[212:215], v[88:91], v[180:183]
    ds_read_b64_tr_b16 v[232:233], v14 offset:36864
    ds_read_b64_tr_b16 v[234:235], v14 offset:38912
    v_mfma_f32_16x16x32_bf16 v[196:199], v[212:215], v[168:171], v[196:199]
    ds_read_b64_tr_b16 v[236:237], v15 offset:36864
    ds_read_b64_tr_b16 v[238:239], v15 offset:38912
    v_mfma_f32_16x16x32_bf16 v[184:187], v[216:219], v[88:91], v[184:187]
    v_mfma_f32_16x16x32_bf16 v[200:203], v[216:219], v[168:171], v[200:203]
    v_mfma_f32_16x16x32_bf16 v[188:191], v[220:223], v[88:91], v[188:191]
    v_mfma_f32_16x16x32_bf16 v[204:207], v[220:223], v[168:171], v[204:207]
    s_waitcnt vmcnt(0) lgkmcnt(0)
    v_mfma_f32_16x16x32_bf16 v[176:179], v[224:227], v[92:95], v[176:179]
    v_mfma_f32_16x16x32_bf16 v[192:195], v[224:227], v[172:175], v[192:195]
    v_mfma_f32_16x16x32_bf16 v[180:183], v[228:231], v[92:95], v[180:183]
    v_mfma_f32_16x16x32_bf16 v[196:199], v[228:231], v[172:175], v[196:199]
    v_mfma_f32_16x16x32_bf16 v[184:187], v[232:235], v[92:95], v[184:187]
    v_mfma_f32_16x16x32_bf16 v[200:203], v[232:235], v[172:175], v[200:203]
    v_mfma_f32_16x16x32_bf16 v[188:191], v[236:239], v[92:95], v[188:191]
    v_mfma_f32_16x16x32_bf16 v[204:207], v[236:239], v[172:175], v[204:207]
    s_barrier
    v_and_b32 v2, 15, v0
    v_lshrrev_b32 v3, 5, v0
    v_bfe_u32 v4, v0, 4, 1
    v_and_b32 v5, 7, v0
    s_lshl_b32 s57, s3, 12
    v_lshl_add_u32 v2, v2, 7, s57
    v_lshl_add_u32 v2, v4, 3, v2
    v_add_u32 v4, 0, v3
    v_xor_b32 v4, v4, v5
    v_lshl_add_u32 v12, v4, 4, v2
    v_add_u32 v4, 2, v3
    v_xor_b32 v4, v4, v5
    v_lshl_add_u32 v13, v4, 4, v2
    v_add_u32 v4, 4, v3
    v_xor_b32 v4, v4, v5
    v_lshl_add_u32 v14, v4, 4, v2
    v_add_u32 v4, 6, v3
    v_xor_b32 v4, v4, v5
    v_lshl_add_u32 v15, v4, 4, v2
    v_cvt_pk_bf16_f32 v16, v176, v177
    v_cvt_pk_bf16_f32 v17, v178, v179
    ds_write_b64 v12, v[16:17] offset:0
    v_cvt_pk_bf16_f32 v20, v180, v181
    v_cvt_pk_bf16_f32 v21, v182, v183
    ds_write_b64 v13, v[20:21] offset:0
    v_cvt_pk_bf16_f32 v24, v184, v185
    v_cvt_pk_bf16_f32 v25, v186, v187
    ds_write_b64 v14, v[24:25] offset:0
    v_cvt_pk_bf16_f32 v28, v188, v189
    v_cvt_pk_bf16_f32 v29, v190, v191
    ds_write_b64 v15, v[28:29] offset:0
    v_cvt_pk_bf16_f32 v18, v192, v193
    v_cvt_pk_bf16_f32 v19, v194, v195
    ds_write_b64 v12, v[18:19] offset:2048
    v_cvt_pk_bf16_f32 v22, v196, v197
    v_cvt_pk_bf16_f32 v23, v198, v199
    ds_write_b64 v13, v[22:23] offset:2048
    v_cvt_pk_bf16_f32 v26, v200, v201
    v_cvt_pk_bf16_f32 v27, v202, v203
    ds_write_b64 v14, v[26:27] offset:2048
    v_cvt_pk_bf16_f32 v30, v204, v205
    v_cvt_pk_bf16_f32 v31, v206, v207
    ds_write_b64 v15, v[30:31] offset:2048
    v_lshrrev_b32 v2, 3, v0
    v_and_b32 v3, 7, v0
    v_xor_b32 v4, v3, v2
    v_lshlrev_b32 v4, 4, v4
    v_lshl_add_u32 v4, v2, 7, v4
    v_add_u32 v4, s57, v4
    s_lshl_b32 s58, s78, 4
    s_mul_i32 s58, s58, 2560
    s_lshl_b32 s59, s67, 7
    s_add_u32 s58, s58, s59
    v_mul_u32_u24 v2, 2560, v2
    v_lshl_add_u32 v2, v3, 4, v2
    v_add_u32 v2, s58, v2
    s_waitcnt lgkmcnt(0)
    ds_read_b128 v[96:99], v4 offset:0
    ds_read_b128 v[100:103], v4 offset:1024
    ds_read_b128 v[104:107], v4 offset:2048
    ds_read_b128 v[108:111], v4 offset:3072
    s_waitcnt lgkmcnt(3)
    s_mov_b32 s58, 0
    buffer_store_dwordx4 v[96:99], v2, s[52:55], s58 offen nt
    s_waitcnt lgkmcnt(2)
    s_mov_b32 s58, 20480
    buffer_store_dwordx4 v[100:103], v2, s[52:55], s58 offen nt
    s_waitcnt lgkmcnt(1)
    s_mov_b32 s58, 40960
    buffer_store_dwordx4 v[104:107], v2, s[52:55], s58 offen nt
    s_waitcnt lgkmcnt(0)
    s_mov_b32 s58, 61440
    buffer_store_dwordx4 v[108:111], v2, s[52:55], s58 offen nt
    s_branch L_fin_6
L_prole_3:
    s_waitcnt lgkmcnt(0)
    s_mov_b32 s8, s36
    s_mov_b32 s9, s37
    s_mov_b32 s10, 0x100
    s_mov_b32 s11, 0x20000
    s_add_u32 s12, s38, 0x780000
    s_addc_u32 s13, s39, 0
    s_mov_b32 s14, 0x10000
    s_mov_b32 s15, 0x20000
    s_mov_b32 s6, 0
    s_sub_u32 s61, s2, 416
    s_and_b32 s62, s61, 7
    s_lshr_b32 s61, s61, 3
    s_mul_i32 s57, s61, 52
    s_lshr_b32 s57, s57, 8
    s_mul_i32 s58, s57, 5
    s_sub_u32 s58, s61, s58
    s_mov_b32 s80, s58
    s_lshr_b32 s4, s62, 1
    s_lshl_b32 s4, s4, 2
    s_add_u32 s4, s4, s57
    s_and_b32 s67, s62, 1
    s_mul_i32 s67, s67, 5
    s_add_u32 s67, s67, s58
    s_mov_b32 s48, s38
    s_mov_b32 s49, s39
    s_mov_b32 s50, 0x280000
    s_mov_b32 s51, 0x20000
    s_mul_i32 s75, s4, 640
    s_lshl_b32 s76, s67, 6
    s_add_u32 s75, s75, s76
    s_add_u32 s75, s75, 32768
    s_and_b32 s76, s62, 1
    s_lshl_b32 s76, s76, 5
    s_add_u32 s75, s75, s76
    s_add_u32 s75, s75, 4
    s_cmp_lg_u32 s3, 0
    s_cbranch_scc1 L_nowait_19
    s_cmp_lg_u32 s6, 0
    s_cbranch_scc1 L_tagok_22
    v_mov_b32 v249, 0
    s_mov_b32 s7, 0
L_tagpoll_23:
    buffer_load_dword v248, v249, s[8:11], 0 offen sc1
    s_waitcnt vmcnt(0)
    v_readfirstlane_b32 s6, v248
    s_nop 1
    s_cmp_lg_u32 s6, 0
    s_cbranch_scc1 L_tagok_22
    s_sleep 16
    s_add_u32 s7, s7, 1
    s_cmp_lt_u32 s7, 262144
    s_cbranch_scc1 L_tagpoll_23
L_tagok_22:
    s_mov_b32 s7, 0
    v_mov_b32 v249, 0
L_poll_20:
    buffer_load_dword v248, v249, s[12:15], s75 offen sc1
    s_waitcnt vmcnt(0)
    v_cmp_ne_u32 vcc, s6, v248
    s_nop 1
    s_cmp_eq_u64 vcc, 0
    s_cbranch_scc1 L_polled_21
    s_sleep 12
    s_add_u32 s7, s7, 1
    s_cmp_lt_u32 s7, 262144
    s_cbranch_scc1 L_poll_20
L_polled_21:
L_nowait_19:
    s_barrier
    s_branch L_worker_4
L_brole_9:
    s_lshr_b32 s4, s2, 4
    s_and_b32 s5, s2, 15
    s_mov_b32 s56, 0xffff0000
    v_and_b32 v1, 7, v0
    v_lshrrev_b32 v2, 3, v0
    s_lshl_b32 s57, s5, 7
    s_lshl_b32 s58, s3, 5
    s_add_u32 s57, s57, s58
    s_mul_i32 s58, s57, 1280
    s_lshl_b32 s59, s4, 7
    s_add_u32 s58, s58, s59
    v_mul_u32_u24 v3, 5120, v2
    v_lshl_add_u32 v3, v1, 4, v3
    v_add_u32 v3, s58, v3
    v_lshl_add_u32 v5, v2, 2, s57
    v_subrev_u32 v4, 3840, v3
    v_cmp_eq_u32 vcc, 0, v5
    v_mov_b32 v5, 0x80000000
    s_nop 0
    v_cndmask_b32 v4, v4, v5, vcc
    s_lshl_b32 s59, s4, 9
    v_lshl_add_u32 v6, v1, 6, s59
    s_waitcnt lgkmcnt(0)
    s_mov_b32 s8, s36
    s_mov_b32 s9, s37
    s_mov_b32 s10, 0x100
    s_mov_b32 s11, 0x20000
    s_add_u32 s12, s38, 0x780000
    s_addc_u32 s13, s39, 0
    s_mov_b32 s14, 0x10000
    s_mov_b32 s15, 0x20000
    s_mov_b32 s6, 0
    s_mov_b32 s40, s24
    s_mov_b32 s41, s25
    s_mov_b32 s42, 0x280000
    s_mov_b32 s43, 0x20000
    s_mov_b32 s44, s26
    s_mov_b32 s45, s27
    s_mov_b32 s46, 0x280000
    s_mov_b32 s47, 0x20000
    s_mov_b32 s48, s28
    s_mov_b32 s49, s29
    s_mov_b32 s50, 0x1400
    s_mov_b32 s51, 0x20000
    s_add_u32 s52, s38, 0x280000
    s_addc_u32 s53, s39, 0
    s_mov_b32 s54, 0x280000
    s_mov_b32 s55, 0x20000
    buffer_load_dwordx4 v[56:59], v6, s[48:51], 0 offen offset:0
    buffer_load_dwordx4 v[60:63], v6, s[48:51], 0 offen offset:16
    buffer_load_dwordx4 v[64:67], v6, s[48:51], 0 offen offset:32
    buffer_load_dwordx4 v[68:71], v6, s[48:51], 0 offen offset:48
    buffer_load_dwordx4 v[12:15], v4, s[40:43], 0 offen offset:0
    buffer_load_dwordx4 v[16:19], v4, s[40:43], 0 offen offset:1280
    buffer_load_dwordx4 v[20:23], v4, s[40:43], 0 offen offset:2560
    buffer_load_dwordx4 v[24:27], v3, s[40:43], 0 offen offset:0
    buffer_load_dwordx4 v[28:31], v3, s[40:43], 0 offen offset:1280
    buffer_load_dwordx4 v[32:35], v3, s[40:43], 0 offen offset:2560
    buffer_load_dwordx4 v[36:39], v3, s[40:43], 0 offen offset:3840
    buffer_load_dwordx4 v[40:43], v3, s[44:47], 0 offen offset:0
    buffer_load_dwordx4 v[44:47], v3, s[44:47], 0 offen offset:1280
    buffer_load_dwordx4 v[48:51], v3, s[44:47], 0 offen offset:2560
    buffer_load_dwordx4 v[52:55], v3, s[44:47], 0 offen offset:3840
    s_lshl_b32 s59, s3, 6
    v_lshl_add_u32 v5, v2, 3, s59
    v_lshl_add_u32 v5, v1, 4, v5
    v_and_b32 v5, 255, v5
    v_lshl_add_u32 v7, v1, 11, v5
    v_and_b32 v5, 15, v0
    v_lshrrev_b32 v10, 4, v0
    s_lshl_b32 s59, s3, 1
    v_add_u32 v8, s59, v5
    v_add_u32 v9, 1, v8
    v_and_b32 v8, 15, v8
    v_and_b32 v9, 15, v9
    v_lshlrev_b32 v8, 4, v8
    v_lshlrev_b32 v9, 4, v9
    s_lshl_b32 s59, s3, 12
    v_lshl_add_u32 v8, v10, 8, v8
    v_lshl_add_u32 v9, v10, 8, v9
    v_add_u32 v8, s59, v8
    v_add_u32 v9, s59, v9
    s_lshl_b32 s59, s4, 6
    s_lshl_b32 s60, s3, 4
    s_add_u32 s59, s59, s60
    s_lshl_b32 s59, s59, 12
    s_lshl_b32 s60, s5, 8
    s_add_u32 s59, s59, s60
    v_lshlrev_b32 v10, 12, v10
    v_lshl_add_u32 v10, v5, 4, v10
    v_add_u32 v10, s59, v10
    s_waitcnt vmcnt(0)
    v_lshlrev_b32 v72, 16, v56
    v_lshlrev_b32 v73, 16, v58
    v_and_b32 v74, s56, v56
    v_and_b32 v75, s56, v58
    v_lshlrev_b32 v76, 16, v57
    v_lshlrev_b32 v77, 16, v59
    v_and_b32 v78, s56, v57
    v_and_b32 v79, s56, v59
    v_lshlrev_b32 v80, 16, v12
    v_and_b32 v81, s56, v12
    v_lshlrev_b32 v82, 16, v16
    v_and_b32 v83, s56, v16
    v_lshlrev_b32 v84, 16, v20
    v_and_b32 v85, s56, v20
    v_lshlrev_b32 v86, 16, v24
    v_and_b32 v87, s56, v24
    v_lshlrev_b32 v88, 16, v28
    v_and_b32 v89, s56, v28
    v_lshlrev_b32 v90, 16, v32
    v_and_b32 v91, s56, v32
    v_lshlrev_b32 v92, 16, v36
    v_and_b32 v93, s56, v36
    v_pk_mul_f32 v[102:103], v[86:87], v[72:73]
    v_pk_mul_f32 v[104:105], v[88:89], v[72:73]
    v_pk_mul_f32 v[106:107], v[90:91], v[72:73]
    v_pk_mul_f32 v[108:109], v[92:93], v[72:73]
    v_lshlrev_b32 v94, 16, v40
    v_and_b32 v95, s56, v40
    v_lshlrev_b32 v96, 16, v44
    v_and_b32 v97, s56, v44
    v_lshlrev_b32 v98, 16, v48
    v_and_b32 v99, s56, v48
    v_lshlrev_b32 v100, 16, v52
    v_and_b32 v101, s56, v52
    v_pk_fma_f32 v[102:103], v[84:85], v[74:75], v[102:103]
    v_pk_fma_f32 v[104:105], v[86:87], v[74:75], v[104:105]
    v_pk_fma_f32 v[106:107], v[88:89], v[74:75], v[106:107]
    v_pk_fma_f32 v[108:109], v[90:91], v[74:75], v[108:109]
    v_pk_fma_f32 v[102:103], v[82:83], v[76:77], v[102:103]
    v_pk_fma_f32 v[104:105], v[84:85], v[76:77], v[104:105]
    v_pk_fma_f32 v[106:107], v[86:87], v[76:77], v[106:107]
    v_pk_fma_f32 v[108:109], v[88:89], v[76:77], v[108:109]
    v_pk_fma_f32 v[102:103], v[80:81], v[78:79], v[102:103]
    v_pk_fma_f32 v[104:105], v[82:83], v[78:79], v[104:105]
    v_pk_fma_f32 v[106:107], v[84:85], v[78:79], v[106:107]
    v_pk_fma_f32 v[108:109], v[86:87], v[78:79], v[108:109]
    v_pk_mul_f32 v[102:103], v[102:103], v[94:95]
    v_pk_mul_f32 v[104:105], v[104:105], v[96:97]
    v_pk_mul_f32 v[106:107], v[106:107], v[98:99]
    v_pk_mul_f32 v[108:109], v[108:109], v[100:101]
    v_cvt_pk_bf16_f32 v110, v102, v104
    v_cvt_pk_bf16_f32 v111, v106, v108
    v_cvt_pk_bf16_f32 v112, v103, v105
    v_cvt_pk_bf16_f32 v113, v107, v109
    ds_write_b64 v7, v[110:111] offset:0
    ds_write_b64 v7, v[112:113] offset:256
    v_lshlrev_b32 v72, 16, v60
    v_lshlrev_b32 v73, 16, v62
    v_and_b32 v74, s56, v60
    v_and_b32 v75, s56, v62
    v_lshlrev_b32 v76, 16, v61
    v_lshlrev_b32 v77, 16, v63
    v_and_b32 v78, s56, v61
    v_and_b32 v79, s56, v63
    v_lshlrev_b32 v80, 16, v13
    v_and_b32 v81, s56, v13
    v_lshlrev_b32 v82, 16, v17
    v_and_b32 v83, s56, v17
    v_lshlrev_b32 v84, 16, v21
    v_and_b32 v85, s56, v21
    v_lshlrev_b32 v86, 16, v25
    v_and_b32 v87, s56, v25
    v_lshlrev_b32 v88, 16, v29
    v_and_b32 v89, s56, v29
    v_lshlrev_b32 v90, 16, v33
    v_and_b32 v91, s56, v33
    v_lshlrev_b32 v92, 16, v37
    v_and_b32 v93, s56, v37
    v_pk_mul_f32 v[102:103], v[86:87], v[72:73]
    v_pk_mul_f32 v[104:105], v[88:89], v[72:73]
    v_pk_mul_f32 v[106:107], v[90:91], v[72:73]
    v_pk_mul_f32 v[108:109], v[92:93], v[72:73]
    v_lshlrev_b32 v94, 16, v41
    v_and_b32 v95, s56, v41
    v_lshlrev_b32 v96, 16, v45
    v_and_b32 v97, s56, v45
    v_lshlrev_b32 v98, 16, v49
    v_and_b32 v99, s56, v49
    v_lshlrev_b32 v100, 16, v53
    v_and_b32 v101, s56, v53
    v_pk_fma_f32 v[102:103], v[84:85], v[74:75], v[102:103]
    v_pk_fma_f32 v[104:105], v[86:87], v[74:75], v[104:105]
    v_pk_fma_f32 v[106:107], v[88:89], v[74:75], v[106:107]
    v_pk_fma_f32 v[108:109], v[90:91], v[74:75], v[108:109]
    v_pk_fma_f32 v[102:103], v[82:83], v[76:77], v[102:103]
    v_pk_fma_f32 v[104:105], v[84:85], v[76:77], v[104:105]
    v_pk_fma_f32 v[106:107], v[86:87], v[76:77], v[106:107]
    v_pk_fma_f32 v[108:109], v[88:89], v[76:77], v[108:109]
    v_pk_fma_f32 v[102:103], v[80:81], v[78:79], v[102:103]
    v_pk_fma_f32 v[104:105], v[82:83], v[78:79], v[104:105]
    v_pk_fma_f32 v[106:107], v[84:85], v[78:79], v[106:107]
    v_pk_fma_f32 v[108:109], v[86:87], v[78:79], v[108:109]
    v_pk_mul_f32 v[102:103], v[102:103], v[94:95]
    v_pk_mul_f32 v[104:105], v[104:105], v[96:97]
    v_pk_mul_f32 v[106:107], v[106:107], v[98:99]
    v_pk_mul_f32 v[108:109], v[108:109], v[100:101]
    v_cvt_pk_bf16_f32 v114, v102, v104
    v_cvt_pk_bf16_f32 v115, v106, v108
    v_cvt_pk_bf16_f32 v116, v103, v105
    v_cvt_pk_bf16_f32 v117, v107, v109
    ds_write_b64 v7, v[114:115] offset:512
    ds_write_b64 v7, v[116:117] offset:768
    v_lshlrev_b32 v72, 16, v64
    v_lshlrev_b32 v73, 16, v66
    v_and_b32 v74, s56, v64
    v_and_b32 v75, s56, v66
    v_lshlrev_b32 v76, 16, v65
    v_lshlrev_b32 v77, 16, v67
    v_and_b32 v78, s56, v65
    v_and_b32 v79, s56, v67
    v_lshlrev_b32 v80, 16, v14
    v_and_b32 v81, s56, v14
    v_lshlrev_b32 v82, 16, v18
    v_and_b32 v83, s56, v18
    v_lshlrev_b32 v84, 16, v22
    v_and_b32 v85, s56, v22
    v_lshlrev_b32 v86, 16, v26
    v_and_b32 v87, s56, v26
    v_lshlrev_b32 v88, 16, v30
    v_and_b32 v89, s56, v30
    v_lshlrev_b32 v90, 16, v34
    v_and_b32 v91, s56, v34
    v_lshlrev_b32 v92, 16, v38
    v_and_b32 v93, s56, v38
    v_pk_mul_f32 v[102:103], v[86:87], v[72:73]
    v_pk_mul_f32 v[104:105], v[88:89], v[72:73]
    v_pk_mul_f32 v[106:107], v[90:91], v[72:73]
    v_pk_mul_f32 v[108:109], v[92:93], v[72:73]
    v_lshlrev_b32 v94, 16, v42
    v_and_b32 v95, s56, v42
    v_lshlrev_b32 v96, 16, v46
    v_and_b32 v97, s56, v46
    v_lshlrev_b32 v98, 16, v50
    v_and_b32 v99, s56, v50
    v_lshlrev_b32 v100, 16, v54
    v_and_b32 v101, s56, v54
    v_pk_fma_f32 v[102:103], v[84:85], v[74:75], v[102:103]
    v_pk_fma_f32 v[104:105], v[86:87], v[74:75], v[104:105]
    v_pk_fma_f32 v[106:107], v[88:89], v[74:75], v[106:107]
    v_pk_fma_f32 v[108:109], v[90:91], v[74:75], v[108:109]
    v_pk_fma_f32 v[102:103], v[82:83], v[76:77], v[102:103]
    v_pk_fma_f32 v[104:105], v[84:85], v[76:77], v[104:105]
    v_pk_fma_f32 v[106:107], v[86:87], v[76:77], v[106:107]
    v_pk_fma_f32 v[108:109], v[88:89], v[76:77], v[108:109]
    v_pk_fma_f32 v[102:103], v[80:81], v[78:79], v[102:103]
    v_pk_fma_f32 v[104:105], v[82:83], v[78:79], v[104:105]
    v_pk_fma_f32 v[106:107], v[84:85], v[78:79], v[106:107]
    v_pk_fma_f32 v[108:109], v[86:87], v[78:79], v[108:109]
    v_pk_mul_f32 v[102:103], v[102:103], v[94:95]
    v_pk_mul_f32 v[104:105], v[104:105], v[96:97]
    v_pk_mul_f32 v[106:107], v[106:107], v[98:99]
    v_pk_mul_f32 v[108:109], v[108:109], v[100:101]
    v_cvt_pk_bf16_f32 v110, v102, v104
    v_cvt_pk_bf16_f32 v111, v106, v108
    v_cvt_pk_bf16_f32 v112, v103, v105
    v_cvt_pk_bf16_f32 v113, v107, v109
    ds_write_b64 v7, v[110:111] offset:1024
    ds_write_b64 v7, v[112:113] offset:1280
    v_lshlrev_b32 v72, 16, v68
    v_lshlrev_b32 v73, 16, v70
    v_and_b32 v74, s56, v68
    v_and_b32 v75, s56, v70
    v_lshlrev_b32 v76, 16, v69
    v_lshlrev_b32 v77, 16, v71
    v_and_b32 v78, s56, v69
    v_and_b32 v79, s56, v71
    v_lshlrev_b32 v80, 16, v15
    v_and_b32 v81, s56, v15
    v_lshlrev_b32 v82, 16, v19
    v_and_b32 v83, s56, v19
    v_lshlrev_b32 v84, 16, v23
    v_and_b32 v85, s56, v23
    v_lshlrev_b32 v86, 16, v27
    v_and_b32 v87, s56, v27
    v_lshlrev_b32 v88, 16, v31
    v_and_b32 v89, s56, v31
    v_lshlrev_b32 v90, 16, v35
    v_and_b32 v91, s56, v35
    v_lshlrev_b32 v92, 16, v39
    v_and_b32 v93, s56, v39
    v_pk_mul_f32 v[102:103], v[86:87], v[72:73]
    v_pk_mul_f32 v[104:105], v[88:89], v[72:73]
    v_pk_mul_f32 v[106:107], v[90:91], v[72:73]
    v_pk_mul_f32 v[108:109], v[92:93], v[72:73]
    v_lshlrev_b32 v94, 16, v43
    v_and_b32 v95, s56, v43
    v_lshlrev_b32 v96, 16, v47
    v_and_b32 v97, s56, v47
    v_lshlrev_b32 v98, 16, v51
    v_and_b32 v99, s56, v51
    v_lshlrev_b32 v100, 16, v55
    v_and_b32 v101, s56, v55
    v_pk_fma_f32 v[102:103], v[84:85], v[74:75], v[102:103]
    v_pk_fma_f32 v[104:105], v[86:87], v[74:75], v[104:105]
    v_pk_fma_f32 v[106:107], v[88:89], v[74:75], v[106:107]
    v_pk_fma_f32 v[108:109], v[90:91], v[74:75], v[108:109]
    v_pk_fma_f32 v[102:103], v[82:83], v[76:77], v[102:103]
    v_pk_fma_f32 v[104:105], v[84:85], v[76:77], v[104:105]
    v_pk_fma_f32 v[106:107], v[86:87], v[76:77], v[106:107]
    v_pk_fma_f32 v[108:109], v[88:89], v[76:77], v[108:109]
    v_pk_fma_f32 v[102:103], v[80:81], v[78:79], v[102:103]
    v_pk_fma_f32 v[104:105], v[82:83], v[78:79], v[104:105]
    v_pk_fma_f32 v[106:107], v[84:85], v[78:79], v[106:107]
    v_pk_fma_f32 v[108:109], v[86:87], v[78:79], v[108:109]
    v_pk_mul_f32 v[102:103], v[102:103], v[94:95]
    v_pk_mul_f32 v[104:105], v[104:105], v[96:97]
    v_pk_mul_f32 v[106:107], v[106:107], v[98:99]
    v_pk_mul_f32 v[108:109], v[108:109], v[100:101]
    v_cvt_pk_bf16_f32 v114, v102, v104
    v_cvt_pk_bf16_f32 v115, v106, v108
    v_cvt_pk_bf16_f32 v116, v103, v105
    v_cvt_pk_bf16_f32 v117, v107, v109
    ds_write_b64 v7, v[114:115] offset:1536
    ds_write_b64 v7, v[116:117] offset:1792
    s_waitcnt lgkmcnt(0)
    s_barrier
    v_mov_b32 v249, 0
    buffer_load_dword v247, v249, s[8:11], 0 offen sc1
    ds_read_b128 v[118:121], v8 offset:0
    ds_read_b128 v[122:125], v8 offset:1024
    ds_read_b128 v[126:129], v9 offset:2048
    ds_read_b128 v[130:133], v9 offset:3072
    s_waitcnt lgkmcnt(3)
    s_mov_b32 s57, 0
    buffer_store_dwordx4 v[118:121], v10, s[52:55], s57 offen sc1
    s_waitcnt lgkmcnt(2)
    s_mov_b32 s57, 16384
    buffer_store_dwordx4 v[122:125], v10, s[52:55], s57 offen sc1
    s_waitcnt lgkmcnt(1)
    s_mov_b32 s57, 32768
    buffer_store_dwordx4 v[126:129], v10, s[52:55], s57 offen sc1
    s_waitcnt lgkmcnt(0)
    s_mov_b32 s57, 49152
    buffer_store_dwordx4 v[130:133], v10, s[52:55], s57 offen sc1
    s_lshl_b32 s70, s4, 7
    s_lshl_b32 s71, s5, 2
    s_add_u32 s71, s71, s70
    s_lshl_b32 s81, s4, 10
    s_add_u32 s81, s81, 43008
    s_lshl_b32 s80, s5, 2
    s_waitcnt vmcnt(0)
    v_readfirstlane_b32 s6, v247
    s_barrier
    s_cmp_lg_u32 s3, 0
    s_cbranch_scc1 L_nosig_25
    s_cmp_lg_u32 s6, 0
    s_cbranch_scc1 L_tagok_26
    v_mov_b32 v249, 0
    s_mov_b32 s7, 0
L_tagpoll_27:
    buffer_load_dword v248, v249, s[8:11], 0 offen sc1
    s_waitcnt vmcnt(0)
    v_readfirstlane_b32 s6, v248
    s_nop 1
    s_cmp_lg_u32 s6, 0
    s_cbranch_scc1 L_tagok_26
    s_sleep 16
    s_add_u32 s7, s7, 1
    s_cmp_lt_u32 s7, 262144
    s_cbranch_scc1 L_tagpoll_27
L_tagok_26:
    v_mov_b32 v248, s6
    v_lshlrev_b32 v249, 6, v0
    v_add_u32 v249, s80, v249
    s_mov_b64 exec, 0xffff
    buffer_store_dword v248, v249, s[12:15], s81 offen sc1
    s_mov_b64 exec, -1
L_nosig_25:
L_b1done_24:
    s_lshl_b32 s69, s4, 6
    s_lshl_b32 s58, s5, 2
    s_add_u32 s69, s69, s58
    s_add_u32 s69, s69, s3
    s_lshr_b32 s58, s69, 1
    s_lshl_b32 s58, s58, 2
    s_load_dword s61, s[32:33], s58
    s_mov_b32 s72, s30
    s_mov_b32 s73, s31
    s_mov_b32 s74, 0x280000
    s_mov_b32 s75, 0x20000
    s_mul_i32 s68, s3, 12608
    s_add_u32 s68, s68, 16384
    s_lshl_b32 s59, s69, 12
    v_lshl_add_u32 v4, v0, 4, s59
    s_add_u32 m0, s68, 4352
    s_mov_b32 s60, 0
    buffer_load_dwordx4 v4, s[72:75], s60 offen  lds
    s_add_u32 m0, s68, 5376
    s_mov_b32 s60, 1024
    buffer_load_dwordx4 v4, s[72:75], s60 offen  lds
    s_add_u32 m0, s68, 6400
    s_mov_b32 s60, 2048
    buffer_load_dwordx4 v4, s[72:75], s60 offen  lds
    s_add_u32 m0, s68, 7424
    s_mov_b32 s60, 3072
    buffer_load_dwordx4 v4, s[72:75], s60 offen  lds
    v_and_b32 v1, 15, v0
    v_lshlrev_b32 v2, 4, v1
    v_add_u32 v3, 4096, v2
    v_cmp_gt_u32 vcc, 10, v1
    s_nop 1
    v_cndmask_b32 v2, v3, v2, vcc
    v_add_u32 v2, s68, v2
    v_mov_b32 v6, 0
    v_mov_b32 v7, 0
    v_mov_b32 v8, 0
    v_mov_b32 v9, 0
    ds_write_b128 v2, v[6:9]
    s_waitcnt lgkmcnt(0)
    s_and_b32 s58, s69, 1
    s_lshl_b32 s59, s61, 16
    s_and_b32 s61, s61, s56
    s_cmp_eq_u32 s58, 0
    s_cselect_b32 s61, s59, s61
    v_lshrrev_b32 v1, 4, v0
    v_bfe_u32 v2, v0, 2, 2
    v_and_b32 v9, 3, v0
    v_lshlrev_b32 v4, 3, v9
    v_lshlrev_b32 v5, 3, v2
    v_sub_u32 v4, v4, v5
    v_lshl_add_u32 v5, v1, 6, v5
    v_lshlrev_b32 v1, 6, v1
    v_sub_u32 v4, v4, v1
    v_lshl_add_u32 v5, v9, 5, v5
    s_add_u32 s58, s68, 224
    v_add_u32 v4, s58, v4
    s_add_u32 s58, s68, 4256
    v_add_u32 v5, s58, v5
    s_add_u32 s58, s68, 160
    v_lshl_add_u32 v6, v0, 1, s58
    s_add_u32 s58, s68, 8448
    v_lshl_add_u32 v7, v0, 1, s58
    v_lshl_add_u32 v8, v0, 4, s58
    s_lshl_b32 s59, s69, 12
    v_lshl_add_u32 v3, v0, 4, s59
    s_add_u32 s40, s38, 0x280000
    s_addc_u32 s41, s39, 0
    s_mov_b32 s42, 0x280000
    s_mov_b32 s43, 0x20000
    s_add_u32 s48, s38, 0x500000
    s_addc_u32 s49, s39, 0
    s_mov_b32 s50, 0x280000
    s_mov_b32 s51, 0x20000
    s_mov_b32 s62, 0
    s_mov_b32 s63, 0x80000000
    s_mov_b32 s64, 0
    s_mov_b32 s65, 0xc0000000
    s_mov_b32 s66, 0
    s_mov_b32 s67, 0xe0000000
    v_mov_b32 v214, 0
    v_mov_b32 v215, 0
    v_mov_b32 v216, 0
    v_mov_b32 v217, 0
    s_waitcnt vmcnt(0)
    ds_read_b64_tr_b16 v[10:11], v5 offset:0
    ds_read_b64_tr_b16 v[12:13], v5 offset:32
    ds_read_b64_tr_b16 v[14:15], v5 offset:256
    ds_read_b64_tr_b16 v[16:17], v5 offset:288
    ds_read_b64_tr_b16 v[18:19], v5 offset:512
    ds_read_b64_tr_b16 v[20:21], v5 offset:544
    ds_read_b64_tr_b16 v[22:23], v5 offset:768
    ds_read_b64_tr_b16 v[24:25], v5 offset:800
    ds_read_b64_tr_b16 v[26:27], v5 offset:1024
    ds_read_b64_tr_b16 v[28:29], v5 offset:1056
    ds_read_b64_tr_b16 v[30:31], v5 offset:1280
    ds_read_b64_tr_b16 v[32:33], v5 offset:1312
    ds_read_b64_tr_b16 v[34:35], v5 offset:1536
    ds_read_b64_tr_b16 v[36:37], v5 offset:1568
    ds_read_b64_tr_b16 v[38:39], v5 offset:1792
    ds_read_b64_tr_b16 v[40:41], v5 offset:1824
    ds_read_b64_tr_b16 v[42:43], v5 offset:2048
    ds_read_b64_tr_b16 v[44:45], v5 offset:2080
    ds_read_b64_tr_b16 v[46:47], v5 offset:2304
    ds_read_b64_tr_b16 v[48:49], v5 offset:2336
    ds_read_b64_tr_b16 v[50:51], v5 offset:2560
    ds_read_b64_tr_b16 v[52:53], v5 offset:2592
    ds_read_b64_tr_b16 v[54:55], v5 offset:2816
    ds_read_b64_tr_b16 v[56:57], v5 offset:2848
    ds_read_b64_tr_b16 v[58:59], v5 offset:3072
    ds_read_b64_tr_b16 v[60:61], v5 offset:3104
    ds_read_b64_tr_b16 v[62:63], v5 offset:3328
    ds_read_b64_tr_b16 v[64:65], v5 offset:3360
    ds_read_b64_tr_b16 v[66:67], v5 offset:3584
    ds_read_b64_tr_b16 v[68:69], v5 offset:3616
    ds_read_b64_tr_b16 v[70:71], v5 offset:3840
    ds_read_b64_tr_b16 v[72:73], v5 offset:3872
    s_lshl_b32 s81, s4, 10
    s_lshl_b32 s80, s5, 6
    s_add_u32 s81, s81, s80
    s_add_u32 s81, s81, 43008
    s_cmp_lg_u32 s3, 0
    s_cbranch_scc1 L_nowait_28
    s_cmp_lg_u32 s6, 0
    s_cbranch_scc1 L_tagok_31
    v_mov_b32 v249, 0
    s_mov_b32 s7, 0
L_tagpoll_32:
    buffer_load_dword v248, v249, s[8:11], 0 offen sc1
    s_waitcnt vmcnt(0)
    v_readfirstlane_b32 s6, v248
    s_nop 1
    s_cmp_lg_u32 s6, 0
    s_cbranch_scc1 L_tagok_31
    s_sleep 16
    s_add_u32 s7, s7, 1
    s_cmp_lt_u32 s7, 262144
    s_cbranch_scc1 L_tagpoll_32
L_tagok_31:
    s_mov_b32 s7, 0
    v_and_b32 v249, 15, v0
    v_lshlrev_b32 v249, 2, v249
L_poll_29:
    buffer_load_dword v248, v249, s[12:15], s81 offen sc1
    s_waitcnt vmcnt(0)
    v_cmp_ne_u32 vcc, s6, v248
    s_nop 1
    s_cmp_eq_u64 vcc, 0
    s_cbranch_scc1 L_polled_30
    s_sleep 12
    s_add_u32 s7, s7, 1
    s_cmp_lt_u32 s7, 262144
    s_cbranch_scc1 L_poll_29
L_polled_30:
L_nowait_28:
    s_barrier
    s_add_u32 m0, s68, 160
    s_mov_b32 s60, 0
    buffer_load_dwordx4 v3, s[40:43], s60 offen  lds
    s_add_u32 m0, s68, 1184
    s_mov_b32 s60, 1024
    buffer_load_dwordx4 v3, s[40:43], s60 offen  lds
    s_add_u32 m0, s68, 2208
    s_mov_b32 s60, 2048
    buffer_load_dwordx4 v3, s[40:43], s60 offen  lds
    s_add_u32 m0, s68, 3232
    s_mov_b32 s60, 3072
    buffer_load_dwordx4 v3, s[40:43], s60 offen  lds
    s_waitcnt vmcnt(3)
    ds_read_b64_tr_b16 v[74:75], v4 offset:32
    ds_read_b64_tr_b16 v[76:77], v4 offset:0
    ds_read_b64_tr_b16 v[78:79], v4 offset:160
    ds_read_b64_tr_b16 v[80:81], v4 offset:128
    ds_read_b64_tr_b16 v[82:83], v4 offset:288
    ds_read_b64_tr_b16 v[84:85], v4 offset:256
    s_waitcnt lgkmcnt(4)
    v_mfma_f32_16x16x32_bf16 v[202:205], v[10:13], v[74:77], 0
    ds_read_b64_tr_b16 v[86:87], v4 offset:416
    ds_read_b64_tr_b16 v[88:89], v4 offset:384
    s_waitcnt lgkmcnt(4)
    v_mfma_f32_16x16x32_bf16 v[206:209], v[10:13], v[78:81], 0
    ds_read_b64_tr_b16 v[90:91], v4 offset:544
    ds_read_b64_tr_b16 v[92:93], v4 offset:512
    s_waitcnt lgkmcnt(4)
    v_mfma_f32_16x16x32_bf16 v[210:213], v[10:13], v[82:85], 0
    ds_read_u16_d16_hi v224, v6 offset:0
    ds_read_u16_d16_hi v225, v6 offset:128
    v_cndmask_b32 v220, v205, v217, s[66:67]
    v_cndmask_b32 v219, v204, v216, s[64:65]
    v_mfma_f32_16x16x32_bf16 v[210:213], v[14:17], v[74:77], v[210:213]
    v_cndmask_b32 v218, v203, v215, s[62:63]
    v_cndmask_b32 v223, v209, v205, s[66:67]
    v_cndmask_b32 v222, v208, v204, s[64:65]
    v_cndmask_b32 v221, v207, v203, s[62:63]
    ds_read_b64_tr_b16 v[94:95], v4 offset:672
    ds_read_b64_tr_b16 v[96:97], v4 offset:640
    s_waitcnt lgkmcnt(6)
    v_mfma_f32_16x16x32_bf16 v[214:217], v[10:13], v[86:89], 0
    v_add_f32_dpp v219, v220, v219 wave_ror:1 row_mask:0xf bank_mask:0xf
    v_add_f32_dpp v222, v223, v222 wave_ror:1 row_mask:0xf bank_mask:0xf
    s_nop 0
    v_add_f32_dpp v218, v219, v218 wave_ror:1 row_mask:0xf bank_mask:0xf
    s_nop 0
    v_add_f32_dpp v221, v222, v221 wave_ror:1 row_mask:0xf bank_mask:0xf
    s_nop 0
    v_add_f32_dpp v226, v218, v202 wave_ror:1 row_mask:0xf bank_mask:0xf
    s_nop 0
    v_add_f32_dpp v227, v221, v206 wave_ror:1 row_mask:0xf bank_mask:0xf
    v_mfma_f32_16x16x32_bf16 v[214:217], v[14:17], v[78:81], v[214:217]
    s_waitcnt lgkmcnt(2)
    v_fma_f32 v226, v224, s61, v226
    v_fma_f32 v227, v225, s61, v227
    v_cvt_pk_bf16_f32 v230, v226, v227
    ds_write_b16 v7, v230 offset:0
    ds_write_b16_d16_hi v7, v230 offset:128
    ds_read_b64_tr_b16 v[98:99], v4 offset:800
    ds_read_b64_tr_b16 v[100:101], v4 offset:768
    s_waitcnt lgkmcnt(8)
    v_mfma_f32_16x16x32_bf16 v[202:205], v[10:13], v[90:93], 0
    ds_read_u16_d16_hi v224, v6 offset:256
    ds_read_u16_d16_hi v225, v6 offset:384
    v_cndmask_b32 v220, v213, v209, s[66:67]
    v_mfma_f32_16x16x32_bf16 v[202:205], v[14:17], v[82:85], v[202:205]
    v_cndmask_b32 v219, v212, v208, s[64:65]
    v_cndmask_b32 v218, v211, v207, s[62:63]
    v_cndmask_b32 v223, v217, v213, s[66:67]
    v_mfma_f32_16x16x32_bf16 v[202:205], v[18:21], v[74:77], v[202:205]
    v_cndmask_b32 v222, v216, v212, s[64:65]
    v_cndmask_b32 v221, v215, v211, s[62:63]
    ds_read_b64_tr_b16 v[102:103], v4 offset:928
    ds_read_b64_tr_b16 v[104:105], v4 offset:896
    s_waitcnt lgkmcnt(8)
    v_mfma_f32_16x16x32_bf16 v[206:209], v[10:13], v[94:97], 0
    v_add_f32_dpp v219, v220, v219 wave_ror:1 row_mask:0xf bank_mask:0xf
    v_add_f32_dpp v222, v223, v222 wave_ror:1 row_mask:0xf bank_mask:0xf
    s_nop 0
    v_add_f32_dpp v218, v219, v218 wave_ror:1 row_mask:0xf bank_mask:0xf
    s_nop 0
    v_add_f32_dpp v221, v222, v221 wave_ror:1 row_mask:0xf bank_mask:0xf
    v_mfma_f32_16x16x32_bf16 v[206:209], v[14:17], v[86:89], v[206:209]
    v_add_f32_dpp v226, v218, v210 wave_ror:1 row_mask:0xf bank_mask:0xf
    v_add_f32_dpp v227, v221, v214 wave_ror:1 row_mask:0xf bank_mask:0xf
    s_waitcnt lgkmcnt(2)
    v_fma_f32 v226, v224, s61, v226
    v_fma_f32 v227, v225, s61, v227
    v_mfma_f32_16x16x32_bf16 v[206:209], v[18:21], v[78:81], v[206:209]
    v_cvt_pk_bf16_f32 v231, v226, v227
    ds_write_b16 v7, v231 offset:256
    ds_write_b16_d16_hi v7, v231 offset:384
    s_waitcnt vmcnt(2)
    ds_read_b64_tr_b16 v[106:107], v4 offset:1056
    ds_read_b64_tr_b16 v[108:109], v4 offset:1024
    s_waitcnt lgkmcnt(8)
    v_mfma_f32_16x16x32_bf16 v[210:213], v[10:13], v[98:101], 0
    ds_read_u16_d16_hi v224, v6 offset:512
    ds_read_u16_d16_hi v225, v6 offset:640
    v_mfma_f32_16x16x32_bf16 v[210:213], v[14:17], v[90:93], v[210:213]
    v_cndmask_b32 v220, v205, v217, s[66:67]
    v_cndmask_b32 v219, v204, v216, s[64:65]
    v_mfma_f32_16x16x32_bf16 v[210:213], v[18:21], v[82:85], v[210:213]
    v_cndmask_b32 v218, v203, v215, s[62:63]
    v_cndmask_b32 v223, v209, v205, s[66:67]
    v_mfma_f32_16x16x32_bf16 v[210:213], v[22:25], v[74:77], v[210:213]
    v_cndmask_b32 v222, v208, v204, s[64:65]
    v_cndmask_b32 v221, v207, v203, s[62:63]
    ds_read_b64_tr_b16 v[110:111], v4 offset:1184
    ds_read_b64_tr_b16 v[112:113], v4 offset:1152
    s_waitcnt lgkmcnt(8)
    v_mfma_f32_16x16x32_bf16 v[214:217], v[10:13], v[102:105], 0
    v_add_f32_dpp v219, v220, v219 wave_ror:1 row_mask:0xf bank_mask:0xf
    v_add_f32_dpp v222, v223, v222 wave_ror:1 row_mask:0xf bank_mask:0xf
    s_nop 0
    v_add_f32_dpp v218, v219, v218 wave_ror:1 row_mask:0xf bank_mask:0xf
    v_mfma_f32_16x16x32_bf16 v[214:217], v[14:17], v[94:97], v[214:217]
    v_add_f32_dpp v221, v222, v221 wave_ror:1 row_mask:0xf bank_mask:0xf
    v_add_f32_dpp v226, v218, v202 wave_ror:1 row_mask:0xf bank_mask:0xf
    s_nop 0
    v_add_f32_dpp v227, v221, v206 wave_ror:1 row_mask:0xf bank_mask:0xf
    v_mfma_f32_16x16x32_bf16 v[214:217], v[18:21], v[86:89], v[214:217]
    s_waitcnt lgkmcnt(2)
    v_fma_f32 v226, v224, s61, v226
    v_fma_f32 v227, v225, s61, v227
    v_cvt_pk_bf16_f32 v230, v226, v227
    v_mfma_f32_16x16x32_bf16 v[214:217], v[22:25], v[78:81], v[214:217]
    ds_write_b16 v7, v230 offset:512
    ds_write_b16_d16_hi v7, v230 offset:640
    ds_read_b64_tr_b16 v[114:115], v4 offset:1312
    ds_read_b64_tr_b16 v[116:117], v4 offset:1280
    s_waitcnt lgkmcnt(8)
    v_mfma_f32_16x16x32_bf16 v[202:205], v[10:13], v[106:109], 0
    ds_read_u16_d16_hi v224, v6 offset:768
    ds_read_u16_d16_hi v225, v6 offset:896
    v_mfma_f32_16x16x32_bf16 v[202:205], v[14:17], v[98:101], v[202:205]
    v_cndmask_b32 v220, v213, v209, s[66:67]
    v_cndmask_b32 v219, v212, v208, s[64:65]
    v_mfma_f32_16x16x32_bf16 v[202:205], v[18:21], v[90:93], v[202:205]
    v_cndmask_b32 v218, v211, v207, s[62:63]
    v_cndmask_b32 v223, v217, v213, s[66:67]
    v_mfma_f32_16x16x32_bf16 v[202:205], v[22:25], v[82:85], v[202:205]
    v_cndmask_b32 v222, v216, v212, s[64:65]
    v_cndmask_b32 v221, v215, v211, s[62:63]
    v_mfma_f32_16x16x32_bf16 v[202:205], v[26:29], v[74:77], v[202:205]
    ds_read_b64_tr_b16 v[118:119], v4 offset:1440
    ds_read_b64_tr_b16 v[120:121], v4 offset:1408
    s_waitcnt lgkmcnt(8)
    v_mfma_f32_16x16x32_bf16 v[206:209], v[10:13], v[110:113], 0
    v_add_f32_dpp v219, v220, v219 wave_ror:1 row_mask:0xf bank_mask:0xf
    v_add_f32_dpp v222, v223, v222 wave_ror:1 row_mask:0xf bank_mask:0xf
    s_nop 0
    v_add_f32_dpp v218, v219, v218 wave_ror:1 row_mask:0xf bank_mask:0xf
    v_mfma_f32_16x16x32_bf16 v[206:209], v[14:17], v[102:105], v[206:209]
    v_add_f32_dpp v221, v222, v221 wave_ror:1 row_mask:0xf bank_mask:0xf
    v_add_f32_dpp v226, v218, v210 wave_ror:1 row_mask:0xf bank_mask:0xf
    s_nop 0
    v_add_f32_dpp v227, v221, v214 wave_ror:1 row_mask:0xf bank_mask:0xf
    v_mfma_f32_16x16x32_bf16 v[206:209], v[18:21], v[94:97], v[206:209]
    s_waitcnt lgkmcnt(2)
    v_fma_f32 v226, v224, s61, v226
    v_fma_f32 v227, v225, s61, v227
    v_cvt_pk_bf16_f32 v231, v226, v227
    v_mfma_f32_16x16x32_bf16 v[206:209], v[22:25], v[86:89], v[206:209]
    ds_write_b16 v7, v231 offset:768
    ds_write_b16_d16_hi v7, v231 offset:896
    ds_read_b128 v[232:235], v8 offset:0
    s_waitcnt lgkmcnt(0)
    s_mov_b32 s60, 0
    buffer_store_dwordx4 v[232:235], v3, s[48:51], s60 offen sc1
    v_mfma_f32_16x16x32_bf16 v[206:209], v[26:29], v[78:81], v[206:209]
    ds_read_b64_tr_b16 v[122:123], v4 offset:1568
    ds_read_b64_tr_b16 v[124:125], v4 offset:1536
    s_waitcnt lgkmcnt(9)
    v_mfma_f32_16x16x32_bf16 v[210:213], v[10:13], v[114:117], 0
    ds_read_u16_d16_hi v224, v6 offset:1024
    ds_read_u16_d16_hi v225, v6 offset:1152
    v_mfma_f32_16x16x32_bf16 v[210:213], v[14:17], v[106:109], v[210:213]
    v_cndmask_b32 v220, v205, v217, s[66:67]
    v_cndmask_b32 v219, v204, v216, s[64:65]
    v_mfma_f32_16x16x32_bf16 v[210:213], v[18:21], v[98:101], v[210:213]
    v_cndmask_b32 v218, v203, v215, s[62:63]
    v_cndmask_b32 v223, v209, v205, s[66:67]
    v_mfma_f32_16x16x32_bf16 v[210:213], v[22:25], v[90:93], v[210:213]
    v_cndmask_b32 v222, v208, v204, s[64:65]
    v_cndmask_b32 v221, v207, v203, s[62:63]
    v_mfma_f32_16x16x32_bf16 v[210:213], v[26:29], v[82:85], v[210:213]
    v_mfma_f32_16x16x32_bf16 v[210:213], v[30:33], v[74:77], v[210:213]
    ds_read_b64_tr_b16 v[126:127], v4 offset:1696
    ds_read_b64_tr_b16 v[128:129], v4 offset:1664
    s_waitcnt lgkmcnt(9)
    v_mfma_f32_16x16x32_bf16 v[214:217], v[10:13], v[118:121], 0
    v_add_f32_dpp v219, v220, v219 wave_ror:1 row_mask:0xf bank_mask:0xf
    v_add_f32_dpp v222, v223, v222 wave_ror:1 row_mask:0xf bank_mask:0xf
    v_mfma_f32_16x16x32_bf16 v[214:217], v[14:17], v[110:113], v[214:217]
    v_add_f32_dpp v218, v219, v218 wave_ror:1 row_mask:0xf bank_mask:0xf
    v_add_f32_dpp v221, v222, v221 wave_ror:1 row_mask:0xf bank_mask:0xf
    v_mfma_f32_16x16x32_bf16 v[214:217], v[18:21], v[102:105], v[214:217]
    v_add_f32_dpp v226, v218, v202 wave_ror:1 row_mask:0xf bank_mask:0xf
    v_add_f32_dpp v227, v221, v206 wave_ror:1 row_mask:0xf bank_mask:0xf
    v_mfma_f32_16x16x32_bf16 v[214:217], v[22:25], v[94:97], v[214:217]
    s_waitcnt lgkmcnt(2)
    v_fma_f32 v226, v224, s61, v226
    v_fma_f32 v227, v225, s61, v227
    v_mfma_f32_16x16x32_bf16 v[214:217], v[26:29], v[86:89], v[214:217]
    v_cvt_pk_bf16_f32 v230, v226, v227
    ds_write_b16 v7, v230 offset:1024
    v_mfma_f32_16x16x32_bf16 v[214:217], v[30:33], v[78:81], v[214:217]
    ds_write_b16_d16_hi v7, v230 offset:1152
    ds_read_b64_tr_b16 v[130:131], v4 offset:1824
    ds_read_b64_tr_b16 v[132:133], v4 offset:1792
    s_waitcnt lgkmcnt(8)
    v_mfma_f32_16x16x32_bf16 v[202:205], v[10:13], v[122:125], 0
    ds_read_u16_d16_hi v224, v6 offset:1280
    ds_read_u16_d16_hi v225, v6 offset:1408
    v_mfma_f32_16x16x32_bf16 v[202:205], v[14:17], v[114:117], v[202:205]
    v_cndmask_b32 v220, v213, v209, s[66:67]
    v_cndmask_b32 v219, v212, v208, s[64:65]
    v_mfma_f32_16x16x32_bf16 v[202:205], v[18:21], v[106:109], v[202:205]
    v_cndmask_b32 v218, v211, v207, s[62:63]
    v_cndmask_b32 v223, v217, v213, s[66:67]
    v_mfma_f32_16x16x32_bf16 v[202:205], v[22:25], v[98:101], v[202:205]
    v_cndmask_b32 v222, v216, v212, s[64:65]
    v_cndmask_b32 v221, v215, v211, s[62:63]
    v_mfma_f32_16x16x32_bf16 v[202:205], v[26:29], v[90:93], v[202:205]
    v_mfma_f32_16x16x32_bf16 v[202:205], v[30:33], v[82:85], v[202:205]
    v_mfma_f32_16x16x32_bf16 v[202:205], v[34:37], v[74:77], v[202:205]
    ds_read_b64_tr_b16 v[134:135], v4 offset:1952
    ds_read_b64_tr_b16 v[136:137], v4 offset:1920
    s_waitcnt lgkmcnt(8)
    v_mfma_f32_16x16x32_bf16 v[206:209], v[10:13], v[126:129], 0
    v_add_f32_dpp v219, v220, v219 wave_ror:1 row_mask:0xf bank_mask:0xf
    v_add_f32_dpp v222, v223, v222 wave_ror:1 row_mask:0xf bank_mask:0xf
    v_mfma_f32_16x16x32_bf16 v[206:209], v[14:17], v[118:121], v[206:209]
    v_add_f32_dpp v218, v219, v218 wave_ror:1 row_mask:0xf bank_mask:0xf
    v_add_f32_dpp v221, v222, v221 wave_ror:1 row_mask:0xf bank_mask:0xf
    v_mfma_f32_16x16x32_bf16 v[206:209], v[18:21], v[110:113], v[206:209]
    v_add_f32_dpp v226, v218, v210 wave_ror:1 row_mask:0xf bank_mask:0xf
    v_add_f32_dpp v227, v221, v214 wave_ror:1 row_mask:0xf bank_mask:0xf
    v_mfma_f32_16x16x32_bf16 v[206:209], v[22:25], v[102:105], v[206:209]
    s_waitcnt lgkmcnt(2)
    v_fma_f32 v226, v224, s61, v226
    v_fma_f32 v227, v225, s61, v227
    v_mfma_f32_16x16x32_bf16 v[206:209], v[26:29], v[94:97], v[206:209]
    v_cvt_pk_bf16_f32 v231, v226, v227
    ds_write_b16 v7, v231 offset:1280
    v_mfma_f32_16x16x32_bf16 v[206:209], v[30:33], v[86:89], v[206:209]
    ds_write_b16_d16_hi v7, v231 offset:1408
    v_mfma_f32_16x16x32_bf16 v[206:209], v[34:37], v[78:81], v[206:209]
    s_waitcnt vmcnt(2)
    ds_read_b64_tr_b16 v[138:139], v4 offset:2080
    ds_read_b64_tr_b16 v[140:141], v4 offset:2048
    s_waitcnt lgkmcnt(8)
    v_mfma_f32_16x16x32_bf16 v[210:213], v[10:13], v[130:133], 0
    ds_read_u16_d16_hi v224, v6 offset:1536
    v_mfma_f32_16x16x32_bf16 v[210:213], v[14:17], v[122:125], v[210:213]
    ds_read_u16_d16_hi v225, v6 offset:1664
    v_mfma_f32_16x16x32_bf16 v[210:213], v[18:21], v[114:117], v[210:213]
    v_cndmask_b32 v220, v205, v217, s[66:67]
    v_mfma_f32_16x16x32_bf16 v[210:213], v[22:25], v[106:109], v[210:213]
    v_cndmask_b32 v219, v204, v216, s[64:65]
    v_mfma_f32_16x16x32_bf16 v[210:213], v[26:29], v[98:101], v[210:213]
    v_cndmask_b32 v218, v203, v215, s[62:63]
    v_mfma_f32_16x16x32_bf16 v[210:213], v[30:33], v[90:93], v[210:213]
    v_cndmask_b32 v223, v209, v205, s[66:67]
    v_mfma_f32_16x16x32_bf16 v[210:213], v[34:37], v[82:85], v[210:213]
    v_cndmask_b32 v222, v208, v204, s[64:65]
    v_mfma_f32_16x16x32_bf16 v[210:213], v[38:41], v[74:77], v[210:213]
    v_cndmask_b32 v221, v207, v203, s[62:63]
    ds_read_b64_tr_b16 v[142:143], v4 offset:2208
    ds_read_b64_tr_b16 v[144:145], v4 offset:2176
    s_waitcnt lgkmcnt(8)
    v_mfma_f32_16x16x32_bf16 v[214:217], v[10:13], v[134:137], 0
    v_add_f32_dpp v219, v220, v219 wave_ror:1 row_mask:0xf bank_mask:0xf
    v_add_f32_dpp v222, v223, v222 wave_ror:1 row_mask:0xf bank_mask:0xf
    v_mfma_f32_16x16x32_bf16 v[214:217], v[14:17], v[126:129], v[214:217]
    v_add_f32_dpp v218, v219, v218 wave_ror:1 row_mask:0xf bank_mask:0xf
    v_add_f32_dpp v221, v222, v221 wave_ror:1 row_mask:0xf bank_mask:0xf
    v_mfma_f32_16x16x32_bf16 v[214:217], v[18:21], v[118:121], v[214:217]
    v_add_f32_dpp v226, v218, v202 wave_ror:1 row_mask:0xf bank_mask:0xf
    v_add_f32_dpp v227, v221, v206 wave_ror:1 row_mask:0xf bank_mask:0xf
    v_mfma_f32_16x16x32_bf16 v[214:217], v[22:25], v[110:113], v[214:217]
    s_waitcnt lgkmcnt(2)
    v_fma_f32 v226, v224, s61, v226
    v_fma_f32 v227, v225, s61, v227
    v_mfma_f32_16x16x32_bf16 v[214:217], v[26:29], v[102:105], v[214:217]
    v_cvt_pk_bf16_f32 v230, v226, v227
    ds_write_b16 v7, v230 offset:1536
    v_mfma_f32_16x16x32_bf16 v[214:217], v[30:33], v[94:97], v[214:217]
    ds_write_b16_d16_hi v7, v230 offset:1664
    v_mfma_f32_16x16x32_bf16 v[214:217], v[34:37], v[86:89], v[214:217]
    v_mfma_f32_16x16x32_bf16 v[214:217], v[38:41], v[78:81], v[214:217]
    ds_read_b64_tr_b16 v[146:147], v4 offset:2336
    ds_read_b64_tr_b16 v[148:149], v4 offset:2304
    s_waitcnt lgkmcnt(8)
    v_mfma_f32_16x16x32_bf16 v[202:205], v[10:13], v[138:141], 0
    ds_read_u16_d16_hi v224, v6 offset:1792
    v_mfma_f32_16x16x32_bf16 v[202:205], v[14:17], v[130:133], v[202:205]
    ds_read_u16_d16_hi v225, v6 offset:1920
    v_mfma_f32_16x16x32_bf16 v[202:205], v[18:21], v[122:125], v[202:205]
    v_cndmask_b32 v220, v213, v209, s[66:67]
    v_mfma_f32_16x16x32_bf16 v[202:205], v[22:25], v[114:117], v[202:205]
    v_cndmask_b32 v219, v212, v208, s[64:65]
    v_mfma_f32_16x16x32_bf16 v[202:205], v[26:29], v[106:109], v[202:205]
    v_cndmask_b32 v218, v211, v207, s[62:63]
    v_mfma_f32_16x16x32_bf16 v[202:205], v[30:33], v[98:101], v[202:205]
    v_cndmask_b32 v223, v217, v213, s[66:67]
    v_mfma_f32_16x16x32_bf16 v[202:205], v[34:37], v[90:93], v[202:205]
    v_cndmask_b32 v222, v216, v212, s[64:65]
    v_mfma_f32_16x16x32_bf16 v[202:205], v[38:41], v[82:85], v[202:205]
    v_cndmask_b32 v221, v215, v211, s[62:63]
    v_mfma_f32_16x16x32_bf16 v[202:205], v[42:45], v[74:77], v[202:205]
    ds_read_b64_tr_b16 v[150:151], v4 offset:2464
    ds_read_b64_tr_b16 v[152:153], v4 offset:2432
    s_waitcnt lgkmcnt(8)
    v_mfma_f32_16x16x32_bf16 v[206:209], v[10:13], v[142:145], 0
    v_add_f32_dpp v219, v220, v219 wave_ror:1 row_mask:0xf bank_mask:0xf
    v_add_f32_dpp v222, v223, v222 wave_ror:1 row_mask:0xf bank_mask:0xf
    v_mfma_f32_16x16x32_bf16 v[206:209], v[14:17], v[134:137], v[206:209]
    v_add_f32_dpp v218, v219, v218 wave_ror:1 row_mask:0xf bank_mask:0xf
    v_add_f32_dpp v221, v222, v221 wave_ror:1 row_mask:0xf bank_mask:0xf
    v_mfma_f32_16x16x32_bf16 v[206:209], v[18:21], v[126:129], v[206:209]
    v_add_f32_dpp v226, v218, v210 wave_ror:1 row_mask:0xf bank_mask:0xf
    v_add_f32_dpp v227, v221, v214 wave_ror:1 row_mask:0xf bank_mask:0xf
    v_mfma_f32_16x16x32_bf16 v[206:209], v[22:25], v[118:121], v[206:209]
    s_waitcnt lgkmcnt(2)
    v_fma_f32 v226, v224, s61, v226
    v_fma_f32 v227, v225, s61, v227
    v_mfma_f32_16x16x32_bf16 v[206:209], v[26:29], v[110:113], v[206:209]
    v_cvt_pk_bf16_f32 v231, v226, v227
    ds_write_b16 v7, v231 offset:1792
    v_mfma_f32_16x16x32_bf16 v[206:209], v[30:33], v[102:105], v[206:209]
    ds_write_b16_d16_hi v7, v231 offset:1920
    ds_read_b128 v[232:235], v8 offset:1024
    s_waitcnt lgkmcnt(0)
    s_mov_b32 s60, 1024
    buffer_store_dwordx4 v[232:235], v3, s[48:51], s60 offen sc1
    v_mfma_f32_16x16x32_bf16 v[206:209], v[34:37], v[94:97], v[206:209]
    v_mfma_f32_16x16x32_bf16 v[206:209], v[38:41], v[86:89], v[206:209]
    v_mfma_f32_16x16x32_bf16 v[206:209], v[42:45], v[78:81], v[206:209]
    ds_read_b64_tr_b16 v[154:155], v4 offset:2592
    ds_read_b64_tr_b16 v[156:157], v4 offset:2560
    s_waitcnt lgkmcnt(9)
    v_mfma_f32_16x16x32_bf16 v[210:213], v[10:13], v[146:149], 0
    ds_read_u16_d16_hi v224, v6 offset:2048
    v_mfma_f32_16x16x32_bf16 v[210:213], v[14:17], v[138:141], v[210:213]
    ds_read_u16_d16_hi v225, v6 offset:2176
    v_mfma_f32_16x16x32_bf16 v[210:213], v[18:21], v[130:133], v[210:213]
    v_cndmask_b32 v220, v205, v217, s[66:67]
    v_mfma_f32_16x16x32_bf16 v[210:213], v[22:25], v[122:125], v[210:213]
    v_cndmask_b32 v219, v204, v216, s[64:65]
    v_mfma_f32_16x16x32_bf16 v[210:213], v[26:29], v[114:117], v[210:213]
    v_cndmask_b32 v218, v203, v215, s[62:63]
    v_mfma_f32_16x16x32_bf16 v[210:213], v[30:33], v[106:109], v[210:213]
    v_cndmask_b32 v223, v209, v205, s[66:67]
    v_mfma_f32_16x16x32_bf16 v[210:213], v[34:37], v[98:101], v[210:213]
    v_cndmask_b32 v222, v208, v204, s[64:65]
    v_mfma_f32_16x16x32_bf16 v[210:213], v[38:41], v[90:93], v[210:213]
    v_cndmask_b32 v221, v207, v203, s[62:63]
    v_mfma_f32_16x16x32_bf16 v[210:213], v[42:45], v[82:85], v[210:213]
    v_mfma_f32_16x16x32_bf16 v[210:213], v[46:49], v[74:77], v[210:213]
    ds_read_b64_tr_b16 v[158:159], v4 offset:2720
    ds_read_b64_tr_b16 v[160:161], v4 offset:2688
    s_waitcnt lgkmcnt(9)
    v_mfma_f32_16x16x32_bf16 v[214:217], v[10:13], v[150:153], 0
    v_add_f32_dpp v219, v220, v219 wave_ror:1 row_mask:0xf bank_mask:0xf
    v_add_f32_dpp v222, v223, v222 wave_ror:1 row_mask:0xf bank_mask:0xf
    v_mfma_f32_16x16x32_bf16 v[214:217], v[14:17], v[142:145], v[214:217]
    v_add_f32_dpp v218, v219, v218 wave_ror:1 row_mask:0xf bank_mask:0xf
    v_add_f32_dpp v221, v222, v221 wave_ror:1 row_mask:0xf bank_mask:0xf
    v_mfma_f32_16x16x32_bf16 v[214:217], v[18:21], v[134:137], v[214:217]
    v_add_f32_dpp v226, v218, v202 wave_ror:1 row_mask:0xf bank_mask:0xf
    v_add_f32_dpp v227, v221, v206 wave_ror:1 row_mask:0xf bank_mask:0xf
    v_mfma_f32_16x16x32_bf16 v[214:217], v[22:25], v[126:129], v[214:217]
    s_waitcnt lgkmcnt(2)
    v_fma_f32 v226, v224, s61, v226
    v_fma_f32 v227, v225, s61, v227
    v_mfma_f32_16x16x32_bf16 v[214:217], v[26:29], v[118:121], v[214:217]
    v_cvt_pk_bf16_f32 v230, v226, v227
    ds_write_b16 v7, v230 offset:2048
    v_mfma_f32_16x16x32_bf16 v[214:217], v[30:33], v[110:113], v[214:217]
    ds_write_b16_d16_hi v7, v230 offset:2176
    v_mfma_f32_16x16x32_bf16 v[214:217], v[34:37], v[102:105], v[214:217]
    v_mfma_f32_16x16x32_bf16 v[214:217], v[38:41], v[94:97], v[214:217]
    v_mfma_f32_16x16x32_bf16 v[214:217], v[42:45], v[86:89], v[214:217]
    v_mfma_f32_16x16x32_bf16 v[214:217], v[46:49], v[78:81], v[214:217]
    ds_read_b64_tr_b16 v[162:163], v4 offset:2848
    ds_read_b64_tr_b16 v[164:165], v4 offset:2816
    s_waitcnt lgkmcnt(8)
    v_mfma_f32_16x16x32_bf16 v[202:205], v[10:13], v[154:157], 0
    ds_read_u16_d16_hi v224, v6 offset:2304
    v_mfma_f32_16x16x32_bf16 v[202:205], v[14:17], v[146:149], v[202:205]
    ds_read_u16_d16_hi v225, v6 offset:2432
    v_mfma_f32_16x16x32_bf16 v[202:205], v[18:21], v[138:141], v[202:205]
    v_cndmask_b32 v220, v213, v209, s[66:67]
    v_mfma_f32_16x16x32_bf16 v[202:205], v[22:25], v[130:133], v[202:205]
    v_cndmask_b32 v219, v212, v208, s[64:65]
    v_mfma_f32_16x16x32_bf16 v[202:205], v[26:29], v[122:125], v[202:205]
    v_cndmask_b32 v218, v211, v207, s[62:63]
    v_mfma_f32_16x16x32_bf16 v[202:205], v[30:33], v[114:117], v[202:205]
    v_cndmask_b32 v223, v217, v213, s[66:67]
    v_mfma_f32_16x16x32_bf16 v[202:205], v[34:37], v[106:109], v[202:205]
    v_cndmask_b32 v222, v216, v212, s[64:65]
    v_mfma_f32_16x16x32_bf16 v[202:205], v[38:41], v[98:101], v[202:205]
    v_cndmask_b32 v221, v215, v211, s[62:63]
    v_mfma_f32_16x16x32_bf16 v[202:205], v[42:45], v[90:93], v[202:205]
    v_mfma_f32_16x16x32_bf16 v[202:205], v[46:49], v[82:85], v[202:205]
    v_mfma_f32_16x16x32_bf16 v[202:205], v[50:53], v[74:77], v[202:205]
    ds_read_b64_tr_b16 v[166:167], v4 offset:2976
    ds_read_b64_tr_b16 v[168:169], v4 offset:2944
    s_waitcnt lgkmcnt(8)
    v_mfma_f32_16x16x32_bf16 v[206:209], v[10:13], v[158:161], 0
    v_add_f32_dpp v219, v220, v219 wave_ror:1 row_mask:0xf bank_mask:0xf
    v_mfma_f32_16x16x32_bf16 v[206:209], v[14:17], v[150:153], v[206:209]
    v_add_f32_dpp v222, v223, v222 wave_ror:1 row_mask:0xf bank_mask:0xf
    v_mfma_f32_16x16x32_bf16 v[206:209], v[18:21], v[142:145], v[206:209]
    v_add_f32_dpp v218, v219, v218 wave_ror:1 row_mask:0xf bank_mask:0xf
    v_mfma_f32_16x16x32_bf16 v[206:209], v[22:25], v[134:137], v[206:209]
    v_add_f32_dpp v221, v222, v221 wave_ror:1 row_mask:0xf bank_mask:0xf
    v_mfma_f32_16x16x32_bf16 v[206:209], v[26:29], v[126:129], v[206:209]
    v_add_f32_dpp v226, v218, v210 wave_ror:1 row_mask:0xf bank_mask:0xf
    v_mfma_f32_16x16x32_bf16 v[206:209], v[30:33], v[118:121], v[206:209]
    v_add_f32_dpp v227, v221, v214 wave_ror:1 row_mask:0xf bank_mask:0xf
    v_mfma_f32_16x16x32_bf16 v[206:209], v[34:37], v[110:113], v[206:209]
    s_waitcnt lgkmcnt(2)
    v_fma_f32 v226, v224, s61, v226
    v_mfma_f32_16x16x32_bf16 v[206:209], v[38:41], v[102:105], v[206:209]
    v_fma_f32 v227, v225, s61, v227
    v_mfma_f32_16x16x32_bf16 v[206:209], v[42:45], v[94:97], v[206:209]
    v_cvt_pk_bf16_f32 v231, v226, v227
    v_mfma_f32_16x16x32_bf16 v[206:209], v[46:49], v[86:89], v[206:209]
    ds_write_b16 v7, v231 offset:2304
    v_mfma_f32_16x16x32_bf16 v[206:209], v[50:53], v[78:81], v[206:209]
    ds_write_b16_d16_hi v7, v231 offset:2432
    s_setprio 3
    s_waitcnt vmcnt(2)
    ds_read_b64_tr_b16 v[170:171], v4 offset:3104
    ds_read_b64_tr_b16 v[172:173], v4 offset:3072
    s_waitcnt lgkmcnt(8)
    v_mfma_f32_16x16x32_bf16 v[210:213], v[10:13], v[162:165], 0
    ds_read_u16_d16_hi v224, v6 offset:2560
    v_mfma_f32_16x16x32_bf16 v[210:213], v[14:17], v[154:157], v[210:213]
    ds_read_u16_d16_hi v225, v6 offset:2688
    v_mfma_f32_16x16x32_bf16 v[210:213], v[18:21], v[146:149], v[210:213]
    v_cndmask_b32 v220, v205, v217, s[66:67]
    v_mfma_f32_16x16x32_bf16 v[210:213], v[22:25], v[138:141], v[210:213]
    v_cndmask_b32 v219, v204, v216, s[64:65]
    v_mfma_f32_16x16x32_bf16 v[210:213], v[26:29], v[130:133], v[210:213]
    v_cndmask_b32 v218, v203, v215, s[62:63]
    v_mfma_f32_16x16x32_bf16 v[210:213], v[30:33], v[122:125], v[210:213]
    v_cndmask_b32 v223, v209, v205, s[66:67]
    v_mfma_f32_16x16x32_bf16 v[210:213], v[34:37], v[114:117], v[210:213]
    v_cndmask_b32 v222, v208, v204, s[64:65]
    v_mfma_f32_16x16x32_bf16 v[210:213], v[38:41], v[106:109], v[210:213]
    v_cndmask_b32 v221, v207, v203, s[62:63]
    v_mfma_f32_16x16x32_bf16 v[210:213], v[42:45], v[98:101], v[210:213]
    v_mfma_f32_16x16x32_bf16 v[210:213], v[46:49], v[90:93], v[210:213]
    v_mfma_f32_16x16x32_bf16 v[210:213], v[50:53], v[82:85], v[210:213]
    v_mfma_f32_16x16x32_bf16 v[210:213], v[54:57], v[74:77], v[210:213]
    ds_read_b64_tr_b16 v[174:175], v4 offset:3232
    ds_read_b64_tr_b16 v[176:177], v4 offset:3200
    s_waitcnt lgkmcnt(8)
    v_mfma_f32_16x16x32_bf16 v[214:217], v[10:13], v[166:169], 0
    v_add_f32_dpp v219, v220, v219 wave_ror:1 row_mask:0xf bank_mask:0xf
    v_mfma_f32_16x16x32_bf16 v[214:217], v[14:17], v[158:161], v[214:217]
    v_add_f32_dpp v222, v223, v222 wave_ror:1 row_mask:0xf bank_mask:0xf
    v_mfma_f32_16x16x32_bf16 v[214:217], v[18:21], v[150:153], v[214:217]
    v_add_f32_dpp v218, v219, v218 wave_ror:1 row_mask:0xf bank_mask:0xf
    v_mfma_f32_16x16x32_bf16 v[214:217], v[22:25], v[142:145], v[214:217]
    v_add_f32_dpp v221, v222, v221 wave_ror:1 row_mask:0xf bank_mask:0xf
    v_mfma_f32_16x16x32_bf16 v[214:217], v[26:29], v[134:137], v[214:217]
    v_add_f32_dpp v226, v218, v202 wave_ror:1 row_mask:0xf bank_mask:0xf
    v_mfma_f32_16x16x32_bf16 v[214:217], v[30:33], v[126:129], v[214:217]
    v_add_f32_dpp v227, v221, v206 wave_ror:1 row_mask:0xf bank_mask:0xf
    v_mfma_f32_16x16x32_bf16 v[214:217], v[34:37], v[118:121], v[214:217]
    s_waitcnt lgkmcnt(2)
    v_fma_f32 v226, v224, s61, v226
    v_mfma_f32_16x16x32_bf16 v[214:217], v[38:41], v[110:113], v[214:217]
    v_fma_f32 v227, v225, s61, v227
    v_mfma_f32_16x16x32_bf16 v[214:217], v[42:45], v[102:105], v[214:217]
    v_cvt_pk_bf16_f32 v230, v226, v227
    v_mfma_f32_16x16x32_bf16 v[214:217], v[46:49], v[94:97], v[214:217]
    ds_write_b16 v7, v230 offset:2560
    v_mfma_f32_16x16x32_bf16 v[214:217], v[50:53], v[86:89], v[214:217]
    ds_write_b16_d16_hi v7, v230 offset:2688
    v_mfma_f32_16x16x32_bf16 v[214:217], v[54:57], v[78:81], v[214:217]
    ds_read_b64_tr_b16 v[178:179], v4 offset:3360
    ds_read_b64_tr_b16 v[180:181], v4 offset:3328
    s_waitcnt lgkmcnt(8)
    v_mfma_f32_16x16x32_bf16 v[202:205], v[10:13], v[170:173], 0
    ds_read_u16_d16_hi v224, v6 offset:2816
    v_mfma_f32_16x16x32_bf16 v[202:205], v[14:17], v[162:165], v[202:205]
    ds_read_u16_d16_hi v225, v6 offset:2944
    v_mfma_f32_16x16x32_bf16 v[202:205], v[18:21], v[154:157], v[202:205]
    v_cndmask_b32 v220, v213, v209, s[66:67]
    v_mfma_f32_16x16x32_bf16 v[202:205], v[22:25], v[146:149], v[202:205]
    v_cndmask_b32 v219, v212, v208, s[64:65]
    v_mfma_f32_16x16x32_bf16 v[202:205], v[26:29], v[138:141], v[202:205]
    v_cndmask_b32 v218, v211, v207, s[62:63]
    v_mfma_f32_16x16x32_bf16 v[202:205], v[30:33], v[130:133], v[202:205]
    v_cndmask_b32 v223, v217, v213, s[66:67]
    v_mfma_f32_16x16x32_bf16 v[202:205], v[34:37], v[122:125], v[202:205]
    v_cndmask_b32 v222, v216, v212, s[64:65]
    v_mfma_f32_16x16x32_bf16 v[202:205], v[38:41], v[114:117], v[202:205]
    v_cndmask_b32 v221, v215, v211, s[62:63]
    v_mfma_f32_16x16x32_bf16 v[202:205], v[42:45], v[106:109], v[202:205]
    v_mfma_f32_16x16x32_bf16 v[202:205], v[46:49], v[98:101], v[202:205]
    v_mfma_f32_16x16x32_bf16 v[202:205], v[50:53], v[90:93], v[202:205]
    v_mfma_f32_16x16x32_bf16 v[202:205], v[54:57], v[82:85], v[202:205]
    v_mfma_f32_16x16x32_bf16 v[202:205], v[58:61], v[74:77], v[202:205]
    ds_read_b64_tr_b16 v[182:183], v4 offset:3488
    ds_read_b64_tr_b16 v[184:185], v4 offset:3456
    s_waitcnt lgkmcnt(8)
    v_mfma_f32_16x16x32_bf16 v[206:209], v[10:13], v[174:177], 0
    v_add_f32_dpp v219, v220, v219 wave_ror:1 row_mask:0xf bank_mask:0xf
    v_mfma_f32_16x16x32_bf16 v[206:209], v[14:17], v[166:169], v[206:209]
    v_add_f32_dpp v222, v223, v222 wave_ror:1 row_mask:0xf bank_mask:0xf
    v_mfma_f32_16x16x32_bf16 v[206:209], v[18:21], v[158:161], v[206:209]
    v_add_f32_dpp v218, v219, v218 wave_ror:1 row_mask:0xf bank_mask:0xf
    v_mfma_f32_16x16x32_bf16 v[206:209], v[22:25], v[150:153], v[206:209]
    v_add_f32_dpp v221, v222, v221 wave_ror:1 row_mask:0xf bank_mask:0xf
    v_mfma_f32_16x16x32_bf16 v[206:209], v[26:29], v[142:145], v[206:209]
    v_add_f32_dpp v226, v218, v210 wave_ror:1 row_mask:0xf bank_mask:0xf
    v_mfma_f32_16x16x32_bf16 v[206:209], v[30:33], v[134:137], v[206:209]
    v_add_f32_dpp v227, v221, v214 wave_ror:1 row_mask:0xf bank_mask:0xf
    v_mfma_f32_16x16x32_bf16 v[206:209], v[34:37], v[126:129], v[206:209]
    s_waitcnt lgkmcnt(2)
    v_fma_f32 v226, v224, s61, v226
    v_mfma_f32_16x16x32_bf16 v[206:209], v[38:41], v[118:121], v[206:209]
    v_fma_f32 v227, v225, s61, v227
    v_mfma_f32_16x16x32_bf16 v[206:209], v[42:45], v[110:113], v[206:209]
    v_cvt_pk_bf16_f32 v231, v226, v227
    v_mfma_f32_16x16x32_bf16 v[206:209], v[46:49], v[102:105], v[206:209]
    ds_write_b16 v7, v231 offset:2816
    v_mfma_f32_16x16x32_bf16 v[206:209], v[50:53], v[94:97], v[206:209]
    ds_write_b16_d16_hi v7, v231 offset:2944
    v_mfma_f32_16x16x32_bf16 v[206:209], v[54:57], v[86:89], v[206:209]
    ds_read_b128 v[232:235], v8 offset:2048
    s_waitcnt lgkmcnt(0)
    s_mov_b32 s60, 2048
    buffer_store_dwordx4 v[232:235], v3, s[48:51], s60 offen sc1
    v_mfma_f32_16x16x32_bf16 v[206:209], v[58:61], v[78:81], v[206:209]
    ds_read_b64_tr_b16 v[186:187], v4 offset:3616
    ds_read_b64_tr_b16 v[188:189], v4 offset:3584
    s_waitcnt lgkmcnt(9)
    v_mfma_f32_16x16x32_bf16 v[210:213], v[10:13], v[178:181], 0
    ds_read_u16_d16_hi v224, v6 offset:3072
    v_mfma_f32_16x16x32_bf16 v[210:213], v[14:17], v[170:173], v[210:213]
    ds_read_u16_d16_hi v225, v6 offset:3200
    v_mfma_f32_16x16x32_bf16 v[210:213], v[18:21], v[162:165], v[210:213]
    v_cndmask_b32 v220, v205, v217, s[66:67]
    v_mfma_f32_16x16x32_bf16 v[210:213], v[22:25], v[154:157], v[210:213]
    v_cndmask_b32 v219, v204, v216, s[64:65]
    v_mfma_f32_16x16x32_bf16 v[210:213], v[26:29], v[146:149], v[210:213]
    v_cndmask_b32 v218, v203, v215, s[62:63]
    v_mfma_f32_16x16x32_bf16 v[210:213], v[30:33], v[138:141], v[210:213]
    v_cndmask_b32 v223, v209, v205, s[66:67]
    v_mfma_f32_16x16x32_bf16 v[210:213], v[34:37], v[130:133], v[210:213]
    v_cndmask_b32 v222, v208, v204, s[64:65]
    v_mfma_f32_16x16x32_bf16 v[210:213], v[38:41], v[122:125], v[210:213]
    v_cndmask_b32 v221, v207, v203, s[62:63]
    v_mfma_f32_16x16x32_bf16 v[210:213], v[42:45], v[114:117], v[210:213]
    v_mfma_f32_16x16x32_bf16 v[210:213], v[46:49], v[106:109], v[210:213]
    v_mfma_f32_16x16x32_bf16 v[210:213], v[50:53], v[98:101], v[210:213]
    v_mfma_f32_16x16x32_bf16 v[210:213], v[54:57], v[90:93], v[210:213]
    v_mfma_f32_16x16x32_bf16 v[210:213], v[58:61], v[82:85], v[210:213]
    v_mfma_f32_16x16x32_bf16 v[210:213], v[62:65], v[74:77], v[210:213]
    ds_read_b64_tr_b16 v[190:191], v4 offset:3744
    ds_read_b64_tr_b16 v[192:193], v4 offset:3712
    s_waitcnt lgkmcnt(9)
    v_mfma_f32_16x16x32_bf16 v[214:217], v[10:13], v[182:185], 0
    v_add_f32_dpp v219, v220, v219 wave_ror:1 row_mask:0xf bank_mask:0xf
    v_mfma_f32_16x16x32_bf16 v[214:217], v[14:17], v[174:177], v[214:217]
    v_add_f32_dpp v222, v223, v222 wave_ror:1 row_mask:0xf bank_mask:0xf
    v_mfma_f32_16x16x32_bf16 v[214:217], v[18:21], v[166:169], v[214:217]
    v_add_f32_dpp v218, v219, v218 wave_ror:1 row_mask:0xf bank_mask:0xf
    v_mfma_f32_16x16x32_bf16 v[214:217], v[22:25], v[158:161], v[214:217]
    v_add_f32_dpp v221, v222, v221 wave_ror:1 row_mask:0xf bank_mask:0xf
    v_mfma_f32_16x16x32_bf16 v[214:217], v[26:29], v[150:153], v[214:217]
    v_add_f32_dpp v226, v218, v202 wave_ror:1 row_mask:0xf bank_mask:0xf
    v_mfma_f32_16x16x32_bf16 v[214:217], v[30:33], v[142:145], v[214:217]
    v_add_f32_dpp v227, v221, v206 wave_ror:1 row_mask:0xf bank_mask:0xf
    v_mfma_f32_16x16x32_bf16 v[214:217], v[34:37], v[134:137], v[214:217]
    s_waitcnt lgkmcnt(2)
    v_fma_f32 v226, v224, s61, v226
    v_mfma_f32_16x16x32_bf16 v[214:217], v[38:41], v[126:129], v[214:217]
    v_fma_f32 v227, v225, s61, v227
    v_mfma_f32_16x16x32_bf16 v[214:217], v[42:45], v[118:121], v[214:217]
    v_cvt_pk_bf16_f32 v230, v226, v227
    v_mfma_f32_16x16x32_bf16 v[214:217], v[46:49], v[110:113], v[214:217]
    ds_write_b16 v7, v230 offset:3072
    v_mfma_f32_16x16x32_bf16 v[214:217], v[50:53], v[102:105], v[214:217]
    ds_write_b16_d16_hi v7, v230 offset:3200
    v_mfma_f32_16x16x32_bf16 v[214:217], v[54:57], v[94:97], v[214:217]
    v_mfma_f32_16x16x32_bf16 v[214:217], v[58:61], v[86:89], v[214:217]
    v_mfma_f32_16x16x32_bf16 v[214:217], v[62:65], v[78:81], v[214:217]
    ds_read_b64_tr_b16 v[194:195], v4 offset:3872
    ds_read_b64_tr_b16 v[196:197], v4 offset:3840
    s_waitcnt lgkmcnt(8)
    v_mfma_f32_16x16x32_bf16 v[202:205], v[10:13], v[186:189], 0
    ds_read_u16_d16_hi v224, v6 offset:3328
    v_mfma_f32_16x16x32_bf16 v[202:205], v[14:17], v[178:181], v[202:205]
    ds_read_u16_d16_hi v225, v6 offset:3456
    v_mfma_f32_16x16x32_bf16 v[202:205], v[18:21], v[170:173], v[202:205]
    v_cndmask_b32 v220, v213, v209, s[66:67]
    v_mfma_f32_16x16x32_bf16 v[202:205], v[22:25], v[162:165], v[202:205]
    v_cndmask_b32 v219, v212, v208, s[64:65]
    v_mfma_f32_16x16x32_bf16 v[202:205], v[26:29], v[154:157], v[202:205]
    v_cndmask_b32 v218, v211, v207, s[62:63]
    v_mfma_f32_16x16x32_bf16 v[202:205], v[30:33], v[146:149], v[202:205]
    v_cndmask_b32 v223, v217, v213, s[66:67]
    v_mfma_f32_16x16x32_bf16 v[202:205], v[34:37], v[138:141], v[202:205]
    v_cndmask_b32 v222, v216, v212, s[64:65]
    v_mfma_f32_16x16x32_bf16 v[202:205], v[38:41], v[130:133], v[202:205]
    v_cndmask_b32 v221, v215, v211, s[62:63]
    v_mfma_f32_16x16x32_bf16 v[202:205], v[42:45], v[122:125], v[202:205]
    v_mfma_f32_16x16x32_bf16 v[202:205], v[46:49], v[114:117], v[202:205]
    v_mfma_f32_16x16x32_bf16 v[202:205], v[50:53], v[106:109], v[202:205]
    v_mfma_f32_16x16x32_bf16 v[202:205], v[54:57], v[98:101], v[202:205]
    v_mfma_f32_16x16x32_bf16 v[202:205], v[58:61], v[90:93], v[202:205]
    v_mfma_f32_16x16x32_bf16 v[202:205], v[62:65], v[82:85], v[202:205]
    v_mfma_f32_16x16x32_bf16 v[202:205], v[66:69], v[74:77], v[202:205]
    ds_read_b64_tr_b16 v[198:199], v4 offset:4000
    ds_read_b64_tr_b16 v[200:201], v4 offset:3968
    s_waitcnt lgkmcnt(8)
    v_mfma_f32_16x16x32_bf16 v[206:209], v[10:13], v[190:193], 0
    v_add_f32_dpp v219, v220, v219 wave_ror:1 row_mask:0xf bank_mask:0xf
    v_mfma_f32_16x16x32_bf16 v[206:209], v[14:17], v[182:185], v[206:209]
    v_add_f32_dpp v222, v223, v222 wave_ror:1 row_mask:0xf bank_mask:0xf
    v_mfma_f32_16x16x32_bf16 v[206:209], v[18:21], v[174:177], v[206:209]
    v_add_f32_dpp v218, v219, v218 wave_ror:1 row_mask:0xf bank_mask:0xf
    v_mfma_f32_16x16x32_bf16 v[206:209], v[22:25], v[166:169], v[206:209]
    v_add_f32_dpp v221, v222, v221 wave_ror:1 row_mask:0xf bank_mask:0xf
    v_mfma_f32_16x16x32_bf16 v[206:209], v[26:29], v[158:161], v[206:209]
    v_add_f32_dpp v226, v218, v210 wave_ror:1 row_mask:0xf bank_mask:0xf
    v_mfma_f32_16x16x32_bf16 v[206:209], v[30:33], v[150:153], v[206:209]
    v_add_f32_dpp v227, v221, v214 wave_ror:1 row_mask:0xf bank_mask:0xf
    v_mfma_f32_16x16x32_bf16 v[206:209], v[34:37], v[142:145], v[206:209]
    s_waitcnt lgkmcnt(2)
    v_fma_f32 v226, v224, s61, v226
    v_mfma_f32_16x16x32_bf16 v[206:209], v[38:41], v[134:137], v[206:209]
    v_fma_f32 v227, v225, s61, v227
    v_mfma_f32_16x16x32_bf16 v[206:209], v[42:45], v[126:129], v[206:209]
    v_cvt_pk_bf16_f32 v231, v226, v227
    v_mfma_f32_16x16x32_bf16 v[206:209], v[46:49], v[118:121], v[206:209]
    ds_write_b16 v7, v231 offset:3328
    v_mfma_f32_16x16x32_bf16 v[206:209], v[50:53], v[110:113], v[206:209]
    ds_write_b16_d16_hi v7, v231 offset:3456
    v_mfma_f32_16x16x32_bf16 v[206:209], v[54:57], v[102:105], v[206:209]
    v_mfma_f32_16x16x32_bf16 v[206:209], v[58:61], v[94:97], v[206:209]
    v_mfma_f32_16x16x32_bf16 v[206:209], v[62:65], v[86:89], v[206:209]
    v_mfma_f32_16x16x32_bf16 v[206:209], v[66:69], v[78:81], v[206:209]
    s_waitcnt lgkmcnt(6)
    v_mfma_f32_16x16x32_bf16 v[210:213], v[10:13], v[194:197], 0
    ds_read_u16_d16_hi v224, v6 offset:3584
    v_mfma_f32_16x16x32_bf16 v[210:213], v[14:17], v[186:189], v[210:213]
    ds_read_u16_d16_hi v225, v6 offset:3712
    v_mfma_f32_16x16x32_bf16 v[210:213], v[18:21], v[178:181], v[210:213]
    v_cndmask_b32 v220, v205, v217, s[66:67]
    v_mfma_f32_16x16x32_bf16 v[210:213], v[22:25], v[170:173], v[210:213]
    v_cndmask_b32 v219, v204, v216, s[64:65]
    v_mfma_f32_16x16x32_bf16 v[210:213], v[26:29], v[162:165], v[210:213]
    v_cndmask_b32 v218, v203, v215, s[62:63]
    v_mfma_f32_16x16x32_bf16 v[210:213], v[30:33], v[154:157], v[210:213]
    v_cndmask_b32 v223, v209, v205, s[66:67]
    v_mfma_f32_16x16x32_bf16 v[210:213], v[34:37], v[146:149], v[210:213]
    v_cndmask_b32 v222, v208, v204, s[64:65]
    v_mfma_f32_16x16x32_bf16 v[210:213], v[38:41], v[138:141], v[210:213]
    v_cndmask_b32 v221, v207, v203, s[62:63]
    v_mfma_f32_16x16x32_bf16 v[210:213], v[42:45], v[130:133], v[210:213]
    v_mfma_f32_16x16x32_bf16 v[210:213], v[46:49], v[122:125], v[210:213]
    v_mfma_f32_16x16x32_bf16 v[210:213], v[50:53], v[114:117], v[210:213]
    v_mfma_f32_16x16x32_bf16 v[210:213], v[54:57], v[106:109], v[210:213]
    v_mfma_f32_16x16x32_bf16 v[210:213], v[58:61], v[98:101], v[210:213]
    v_mfma_f32_16x16x32_bf16 v[210:213], v[62:65], v[90:93], v[210:213]
    v_mfma_f32_16x16x32_bf16 v[210:213], v[66:69], v[82:85], v[210:213]
    v_mfma_f32_16x16x32_bf16 v[210:213], v[70:73], v[74:77], v[210:213]
    s_waitcnt lgkmcnt(4)
    v_mfma_f32_16x16x32_bf16 v[214:217], v[10:13], v[198:201], 0
    v_add_f32_dpp v219, v220, v219 wave_ror:1 row_mask:0xf bank_mask:0xf
    v_mfma_f32_16x16x32_bf16 v[214:217], v[14:17], v[190:193], v[214:217]
    v_add_f32_dpp v222, v223, v222 wave_ror:1 row_mask:0xf bank_mask:0xf
    v_mfma_f32_16x16x32_bf16 v[214:217], v[18:21], v[182:185], v[214:217]
    v_add_f32_dpp v218, v219, v218 wave_ror:1 row_mask:0xf bank_mask:0xf
    v_mfma_f32_16x16x32_bf16 v[214:217], v[22:25], v[174:177], v[214:217]
    v_add_f32_dpp v221, v222, v221 wave_ror:1 row_mask:0xf bank_mask:0xf
    v_mfma_f32_16x16x32_bf16 v[214:217], v[26:29], v[166:169], v[214:217]
    v_add_f32_dpp v226, v218, v202 wave_ror:1 row_mask:0xf bank_mask:0xf
    v_mfma_f32_16x16x32_bf16 v[214:217], v[30:33], v[158:161], v[214:217]
    v_add_f32_dpp v227, v221, v206 wave_ror:1 row_mask:0xf bank_mask:0xf
    v_mfma_f32_16x16x32_bf16 v[214:217], v[34:37], v[150:153], v[214:217]
    s_waitcnt lgkmcnt(0)
    v_fma_f32 v226, v224, s61, v226
    v_mfma_f32_16x16x32_bf16 v[214:217], v[38:41], v[142:145], v[214:217]
    v_fma_f32 v227, v225, s61, v227
    v_mfma_f32_16x16x32_bf16 v[214:217], v[42:45], v[134:137], v[214:217]
    v_cvt_pk_bf16_f32 v230, v226, v227
    v_mfma_f32_16x16x32_bf16 v[214:217], v[46:49], v[126:129], v[214:217]
    ds_write_b16 v7, v230 offset:3584
    v_mfma_f32_16x16x32_bf16 v[214:217], v[50:53], v[118:121], v[214:217]
    ds_write_b16_d16_hi v7, v230 offset:3712
    v_mfma_f32_16x16x32_bf16 v[214:217], v[54:57], v[110:113], v[214:217]
    v_mfma_f32_16x16x32_bf16 v[214:217], v[58:61], v[102:105], v[214:217]
    v_mfma_f32_16x16x32_bf16 v[214:217], v[62:65], v[94:97], v[214:217]
    v_mfma_f32_16x16x32_bf16 v[214:217], v[66:69], v[86:89], v[214:217]
    v_mfma_f32_16x16x32_bf16 v[214:217], v[70:73], v[78:81], v[214:217]
    ds_read_u16_d16_hi v224, v6 offset:3840
    ds_read_u16_d16_hi v225, v6 offset:3968
    v_cndmask_b32 v220, v213, v209, s[66:67]
    v_cndmask_b32 v219, v212, v208, s[64:65]
    v_cndmask_b32 v218, v211, v207, s[62:63]
    s_nop 2
    v_cndmask_b32 v223, v217, v213, s[66:67]
    s_nop 1
    v_cndmask_b32 v222, v216, v212, s[64:65]
    s_nop 0
    v_cndmask_b32 v221, v215, v211, s[62:63]
    v_add_f32_dpp v219, v220, v219 wave_ror:1 row_mask:0xf bank_mask:0xf
    v_add_f32_dpp v222, v223, v222 wave_ror:1 row_mask:0xf bank_mask:0xf
    s_nop 0
    v_add_f32_dpp v218, v219, v218 wave_ror:1 row_mask:0xf bank_mask:0xf
    s_nop 0
    v_add_f32_dpp v221, v222, v221 wave_ror:1 row_mask:0xf bank_mask:0xf
    s_nop 0
    v_add_f32_dpp v226, v218, v210 wave_ror:1 row_mask:0xf bank_mask:0xf
    s_nop 0
    v_add_f32_dpp v227, v221, v214 wave_ror:1 row_mask:0xf bank_mask:0xf
    s_waitcnt lgkmcnt(0)
    v_fma_f32 v226, v224, s61, v226
    v_fma_f32 v227, v225, s61, v227
    v_cvt_pk_bf16_f32 v231, v226, v227
    ds_write_b16 v7, v231 offset:3840
    ds_write_b16_d16_hi v7, v231 offset:3968
    ds_read_b128 v[232:235], v8 offset:3072
    s_waitcnt lgkmcnt(0)
    s_mov_b32 s60, 3072
    buffer_store_dwordx4 v[232:235], v3, s[48:51], s60 offen sc1
    s_lshl_b32 s81, s4, 10
    s_add_u32 s81, s81, 53248
    s_lshl_b32 s80, s5, 2
    s_waitcnt vmcnt(0)
    s_barrier
    s_cmp_lg_u32 s3, 0
    s_cbranch_scc1 L_nosig_33
    s_cmp_lg_u32 s6, 0
    s_cbranch_scc1 L_tagok_34
    v_mov_b32 v249, 0
    s_mov_b32 s7, 0
L_tagpoll_35:
    buffer_load_dword v248, v249, s[8:11], 0 offen sc1
    s_waitcnt vmcnt(0)
    v_readfirstlane_b32 s6, v248
    s_nop 1
    s_cmp_lg_u32 s6, 0
    s_cbranch_scc1 L_tagok_34
    s_sleep 16
    s_add_u32 s7, s7, 1
    s_cmp_lt_u32 s7, 262144
    s_cbranch_scc1 L_tagpoll_35
L_tagok_34:
    v_mov_b32 v248, s6
    v_lshlrev_b32 v249, 6, v0
    v_add_u32 v249, s80, v249
    s_mov_b64 exec, 0xffff
    buffer_store_dword v248, v249, s[12:15], s81 offen sc1
    s_mov_b64 exec, -1
L_nosig_33:
    s_setprio 3
    s_mov_b32 s40, s22
    s_mov_b32 s41, s23
    s_mov_b32 s42, 0x280000
    s_mov_b32 s43, 0x20000
    s_add_u32 s44, s38, 0x500000
    s_addc_u32 s45, s39, 0
    s_mov_b32 s46, 0x280000
    s_mov_b32 s47, 0x20000
    s_mov_b32 s48, s34
    s_mov_b32 s49, s35
    s_mov_b32 s50, 0x500000
    s_mov_b32 s51, 0x20000
    v_and_b32 v1, 7, v0
    v_lshrrev_b32 v2, 3, v0
    s_lshl_b32 s57, s5, 7
    s_lshl_b32 s58, s3, 5
    s_add_u32 s57, s57, s58
    v_add_u32 v3, s57, v2
    s_lshl_b32 s59, s4, 7
    v_lshl_add_u32 v7, v1, 4, s59
    v_mul_u32_u24 v4, 1280, v3
    v_add_u32 v4, v4, v7
    v_mul_u32_u24 v6, 2560, v3
    v_add_u32 v6, v6, v7
    v_add_u32 v6, 1280, v6
    s_mov_b32 s58, 0
    buffer_load_dwordx4 v[12:15], v4, s[40:43], s58 offen
    s_mov_b32 s58, 10240
    buffer_load_dwordx4 v[16:19], v4, s[40:43], s58 offen
    s_mov_b32 s58, 20480
    buffer_load_dwordx4 v[20:23], v4, s[40:43], s58 offen
    s_mov_b32 s58, 30720
    buffer_load_dwordx4 v[24:27], v4, s[40:43], s58 offen
    v_and_b32 v3, 15, v0
    v_lshrrev_b32 v7, 4, v0
    s_lshl_b32 s58, s4, 6
    s_lshl_b32 s59, s3, 4
    s_add_u32 s58, s58, s59
    s_lshl_b32 s58, s58, 12
    s_lshl_b32 s59, s5, 8
    s_add_u32 s58, s58, s59
    v_lshlrev_b32 v7, 12, v7
    v_add_u32 v7, s58, v7
    s_lshl_b32 s59, s3, 1
    v_subrev_u32 v5, s59, v3
    v_and_b32 v5, 15, v5
    v_lshl_add_u32 v5, v5, 4, v7
    v_subrev_u32 v68, s59, v3
    v_subrev_u32 v68, 1, v68
    v_and_b32 v68, 15, v68
    v_lshl_add_u32 v68, v68, 4, v7
    s_lshl_b32 s60, s3, 6
    v_lshl_add_u32 v3, v1, 4, s60
    v_and_b32 v3, 255, v3
    v_lshl_add_u32 v3, v2, 1, v3
    v_lshl_add_u32 v8, v1, 11, v3
    v_lshl_add_u32 v3, v1, 4, s60
    v_add_u32 v3, 16, v3
    v_and_b32 v3, 255, v3
    v_lshl_add_u32 v3, v2, 1, v3
    v_lshl_add_u32 v9, v1, 11, v3
    v_lshl_add_u32 v3, v1, 4, s60
    v_add_u32 v3, 32, v3
    v_and_b32 v3, 255, v3
    v_lshl_add_u32 v3, v2, 1, v3
    v_lshl_add_u32 v10, v1, 11, v3
    v_lshl_add_u32 v3, v1, 4, s60
    v_add_u32 v3, 48, v3
    v_and_b32 v3, 255, v3
    v_lshl_add_u32 v3, v2, 1, v3
    v_lshl_add_u32 v11, v1, 11, v3
    s_lshl_b32 s62, s3, 12
    s_waitcnt vmcnt(3)
    v_lshlrev_b32 v70, 16, v12
    v_and_b32 v71, s56, v12
    v_lshlrev_b32 v72, 16, v13
    v_and_b32 v73, s56, v13
    v_lshlrev_b32 v74, 16, v14
    v_and_b32 v75, s56, v14
    v_lshlrev_b32 v76, 16, v15
    v_and_b32 v77, s56, v15
    s_waitcnt vmcnt(2)
    v_lshlrev_b32 v78, 16, v16
    v_and_b32 v79, s56, v16
    v_lshlrev_b32 v80, 16, v17
    v_and_b32 v81, s56, v17
    v_lshlrev_b32 v82, 16, v18
    v_and_b32 v83, s56, v18
    v_lshlrev_b32 v84, 16, v19
    v_and_b32 v85, s56, v19
    s_waitcnt vmcnt(1)
    v_lshlrev_b32 v86, 16, v20
    v_and_b32 v87, s56, v20
    v_lshlrev_b32 v88, 16, v21
    v_and_b32 v89, s56, v21
    v_lshlrev_b32 v90, 16, v22
    v_and_b32 v91, s56, v22
    v_lshlrev_b32 v92, 16, v23
    v_and_b32 v93, s56, v23
    s_waitcnt vmcnt(0)
    v_lshlrev_b32 v94, 16, v24
    v_and_b32 v95, s56, v24
    v_lshlrev_b32 v96, 16, v25
    v_and_b32 v97, s56, v25
    v_lshlrev_b32 v98, 16, v26
    v_and_b32 v99, s56, v26
    v_lshlrev_b32 v100, 16, v27
    v_and_b32 v101, s56, v27
    s_mov_b32 s63, 0
    s_mov_b32 s64, 16384
    s_mov_b32 s65, 32768
    s_mov_b32 s66, 49152
    s_lshl_b32 s81, s4, 10
    s_lshl_b32 s80, s5, 6
    s_add_u32 s81, s81, s80
    s_add_u32 s81, s81, 53248
    s_cmp_lg_u32 s3, 0
    s_cbranch_scc1 L_nowait_36
    s_cmp_lg_u32 s6, 0
    s_cbranch_scc1 L_tagok_39
    v_mov_b32 v249, 0
    s_mov_b32 s7, 0
L_tagpoll_40:
    buffer_load_dword v248, v249, s[8:11], 0 offen sc1
    s_waitcnt vmcnt(0)
    v_readfirstlane_b32 s6, v248
    s_nop 1
    s_cmp_lg_u32 s6, 0
    s_cbranch_scc1 L_tagok_39
    s_sleep 16
    s_add_u32 s7, s7, 1
    s_cmp_lt_u32 s7, 262144
    s_cbranch_scc1 L_tagpoll_40
L_tagok_39:
    s_mov_b32 s7, 0
    v_and_b32 v249, 15, v0
    v_lshlrev_b32 v249, 2, v249
L_poll_37:
    buffer_load_dword v248, v249, s[12:15], s81 offen sc1
    s_waitcnt vmcnt(0)
    v_cmp_ne_u32 vcc, s6, v248
    s_nop 1
    s_cmp_eq_u64 vcc, 0
    s_cbranch_scc1 L_polled_38
    s_sleep 12
    s_add_u32 s7, s7, 1
    s_cmp_lt_u32 s7, 262144
    s_cbranch_scc1 L_poll_37
L_polled_38:
L_nowait_36:
    s_barrier
    s_add_u32 m0, s62, 0
    s_nop 0
    buffer_load_dwordx4 v5, s[44:47], s63 offen  lds
    s_add_u32 m0, s62, 1024
    s_nop 0
    buffer_load_dwordx4 v5, s[44:47], s64 offen  lds
    s_add_u32 m0, s62, 2048
    s_nop 0
    buffer_load_dwordx4 v68, s[44:47], s65 offen  lds
    s_add_u32 m0, s62, 3072
    s_nop 0
    buffer_load_dwordx4 v68, s[44:47], s66 offen  lds
    s_mov_b32 s63, 0
    s_mov_b32 s64, 20480
    s_mov_b32 s65, 40960
    s_mov_b32 s66, 61440
    s_waitcnt vmcnt(0)
    s_barrier
    ds_read_u16_d16_hi v28, v8 offset:0
    ds_read_u16_d16_hi v29, v8 offset:256
    ds_read_u16_d16_hi v30, v8 offset:512
    ds_read_u16_d16_hi v31, v8 offset:768
    ds_read_u16_d16_hi v32, v8 offset:1024
    ds_read_u16_d16_hi v33, v8 offset:1280
    ds_read_u16_d16_hi v34, v8 offset:1536
    ds_read_u16_d16_hi v35, v8 offset:1792
    ds_read_u16_d16_hi v36, v9 offset:0
    ds_read_u16_d16_hi v37, v9 offset:256
    ds_read_u16_d16_hi v38, v9 offset:512
    ds_read_u16_d16_hi v39, v9 offset:768
    ds_read_u16_d16_hi v40, v9 offset:1024
    ds_read_u16_d16_hi v41, v9 offset:1280
    ds_read_u16_d16_hi v42, v9 offset:1536
    ds_read_u16_d16_hi v43, v9 offset:1792
    ds_read_u16_d16_hi v44, v10 offset:0
    ds_read_u16_d16_hi v45, v10 offset:256
    ds_read_u16_d16_hi v46, v10 offset:512
    ds_read_u16_d16_hi v47, v10 offset:768
    ds_read_u16_d16_hi v48, v10 offset:1024
    ds_read_u16_d16_hi v49, v10 offset:1280
    ds_read_u16_d16_hi v50, v10 offset:1536
    ds_read_u16_d16_hi v51, v10 offset:1792
    ds_read_u16_d16_hi v52, v11 offset:0
    ds_read_u16_d16_hi v53, v11 offset:256
    ds_read_u16_d16_hi v54, v11 offset:512
    ds_read_u16_d16_hi v55, v11 offset:768
    ds_read_u16_d16_hi v56, v11 offset:1024
    ds_read_u16_d16_hi v57, v11 offset:1280
    ds_read_u16_d16_hi v58, v11 offset:1536
    ds_read_u16_d16_hi v59, v11 offset:1792
    s_waitcnt lgkmcnt(15)
    v_pk_mul_f32 v[70:71], v[70:71], v[28:29]
    v_pk_mul_f32 v[72:73], v[72:73], v[30:31]
    v_pk_mul_f32 v[74:75], v[74:75], v[32:33]
    v_pk_mul_f32 v[76:77], v[76:77], v[34:35]
    v_cvt_pk_bf16_f32 v60, v70, v71
    v_cvt_pk_bf16_f32 v61, v72, v73
    v_cvt_pk_bf16_f32 v62, v74, v75
    v_cvt_pk_bf16_f32 v63, v76, v77
    buffer_store_dwordx4 v[60:63], v6, s[48:51], s63 offen nt
    s_waitcnt lgkmcnt(15)
    v_pk_mul_f32 v[78:79], v[78:79], v[36:37]
    v_pk_mul_f32 v[80:81], v[80:81], v[38:39]
    v_pk_mul_f32 v[82:83], v[82:83], v[40:41]
    v_pk_mul_f32 v[84:85], v[84:85], v[42:43]
    v_cvt_pk_bf16_f32 v64, v78, v79
    v_cvt_pk_bf16_f32 v65, v80, v81
    v_cvt_pk_bf16_f32 v66, v82, v83
    v_cvt_pk_bf16_f32 v67, v84, v85
    buffer_store_dwordx4 v[64:67], v6, s[48:51], s64 offen nt
    s_waitcnt lgkmcnt(8)
    v_pk_mul_f32 v[86:87], v[86:87], v[44:45]
    v_pk_mul_f32 v[88:89], v[88:89], v[46:47]
    v_pk_mul_f32 v[90:91], v[90:91], v[48:49]
    v_pk_mul_f32 v[92:93], v[92:93], v[50:51]
    v_cvt_pk_bf16_f32 v60, v86, v87
    v_cvt_pk_bf16_f32 v61, v88, v89
    v_cvt_pk_bf16_f32 v62, v90, v91
    v_cvt_pk_bf16_f32 v63, v92, v93
    buffer_store_dwordx4 v[60:63], v6, s[48:51], s65 offen nt
    s_waitcnt lgkmcnt(0)
    v_pk_mul_f32 v[94:95], v[94:95], v[52:53]
    v_pk_mul_f32 v[96:97], v[96:97], v[54:55]
    v_pk_mul_f32 v[98:99], v[98:99], v[56:57]
    v_pk_mul_f32 v[100:101], v[100:101], v[58:59]
    v_cvt_pk_bf16_f32 v64, v94, v95
    v_cvt_pk_bf16_f32 v65, v96, v97
    v_cvt_pk_bf16_f32 v66, v98, v99
    v_cvt_pk_bf16_f32 v67, v100, v101
    buffer_store_dwordx4 v[64:67], v6, s[48:51], s66 offen nt
L_fin_6:
L_end_1:
    s_endpgm
.section .rodata,"a"
.p2align 6
.amdhsa_kernel concat_heads__sliding_local_dilated__ssm_conv_h3__prompt_kernel
  .amdhsa_next_free_vgpr 256
  .amdhsa_next_free_sgpr 102
  .amdhsa_accum_offset 256
  .amdhsa_group_segment_fixed_size 0
  .amdhsa_kernarg_size 96
  .amdhsa_user_sgpr_count 2
  .amdhsa_user_sgpr_kernarg_segment_ptr 1
  .amdhsa_system_sgpr_workgroup_id_x 1
  .amdhsa_float_denorm_mode_32 3
.end_amdhsa_kernel
.text
```
